```python
import torch

def _softmax(x, axis=-1):
    return torch.softmax(x, dim=axis)
def _gelu(x):
    return torch.nn.functional.gelu(x, approximate="tanh")
def _silu(x):
    return torch.nn.functional.silu(x)
def _sigmoid(x):
    return torch.sigmoid(x)
def _layernorm(x, axis=-1, eps=1e-5):
    m = x.mean(dim=axis, keepdim=True)
    v = x.var(dim=axis, keepdim=True, unbiased=False)
    return (x - m) / torch.sqrt(v + eps)
def _scatter_add(tgt, idx, src, axis=0):
    return tgt.clone().index_add_(axis, idx, src)
def _segment_sum(src, seg, n):
    out = torch.zeros((n,) + src.shape[1:], dtype=src.dtype)
    return out.index_add_(0, seg, src)
def _pad(x, pw):
    flat = tuple(v for pair in reversed(pw) for v in pair)
    return torch.nn.functional.pad(x, flat)

kernel_name = 'gated_mix__ssm_conv_h3__grouped_kv_mqa__prompt'

def setup_inputs():

    _w = (lambda a: (lambda t: t.to(torch.bfloat16) if t.is_floating_point() else t)(torch.as_tensor(a)))
    def _A_setup():
        B, S, D = 1, 2048, 1024
        ks = 4
        return {
            "q": _w((lambda *s: torch.randn(*s, dtype=torch.bfloat16) * 0.05)(B, S, D)),
            "k": _w((lambda *s: torch.randn(*s, dtype=torch.bfloat16) * 0.4)(B, S, D)),
            "v": _w((lambda *s: torch.randn(*s, dtype=torch.bfloat16) * 0.4)(B, S, D)),
            "shift_k": _w((lambda *s: torch.randn(*s, dtype=torch.bfloat16) * 0.4)(D, ks) * 0.5),
            "ssm_k": _w((lambda *s: torch.randn(*s, dtype=torch.bfloat16) * 0.8)(D, S) * (1.0 / S ** 0.5)),
            "ssm_D": _w((lambda *s: torch.randn(*s, dtype=torch.bfloat16) * 0.4)(D)),
        }
    _A_in = _A_setup()

    def _B_setup():
        B, S, D, H = 1, 2048, 1024, 32
        Dh = D // H
        return {
            "x": _w((lambda *s: torch.randn(*s, dtype=torch.bfloat16) * 0.05)(B, S, D)),
            "wq": _w((lambda *s: torch.randn(*s, dtype=torch.bfloat16) * 0.8)(D, H * Dh)),
            "wk": _w((lambda *s: torch.randn(*s, dtype=torch.bfloat16) * 0.8)(D, Dh)),
            "wv": _w((lambda *s: torch.randn(*s, dtype=torch.bfloat16) * 0.05)(D, Dh)),
            "wo": _w((lambda *s: torch.randn(*s, dtype=torch.bfloat16) * 0.05)(H * Dh, D)),
        }
    _B_in = _B_setup()

    return {
        "A_q": _A_in["q"],
        "A_k": _A_in["k"],
        "A_v": _A_in["v"],
        "A_shift_k": _A_in["shift_k"],
        "A_ssm_k": _A_in["ssm_k"],
        "A_ssm_D": _A_in["ssm_D"],
        "B_x": _B_in["x"],
        "B_wq": _B_in["wq"],
        "B_wk": _B_in["wk"],
        "B_wv": _B_in["wv"],
        "B_wo": _B_in["wo"],
        "gate_w": _w((lambda *s: torch.randn(*s, dtype=torch.bfloat16) * 0.05)(1024) * 16.0),
    }

def reference(A_q, A_k, A_v, A_shift_k, A_ssm_k, A_ssm_D, B_x, B_wq, B_wk, B_wv, B_wo, gate_w):
    def _A_ref(q, k, v, shift_k, ssm_k, ssm_D):
        B, S, D = q.shape
        ks = shift_k.shape[-1]
        k_pad = _pad(k, ((0, 0), (ks - 1, 0), (0, 0)))
        k_shift = torch.zeros_like(k)
        for t in range(ks):
            k_shift = k_shift + k_pad[:, t:t + S, :] * shift_k[:, ks - 1 - t][None, None, :]
        kv = k_shift * v
        L = 2 * S
        kv_pad = _pad(kv, ((0, 0), (0, S), (0, 0)))
        kf_pad = _pad(ssm_k, ((0, 0), (0, S)))
        kv_f = (lambda x, axes=(-2,-1): torch.fft.rfft2(x.float(), dim=axes))(kv_pad[:, None, :, :], axes=(1, 2))
        kf_f = (lambda x, axes=(-2,-1): torch.fft.rfft2(x.float(), dim=axes))(kf_pad[:, None, :], axes=(1, 2))
        kf_f = (lambda x, *d: x.permute(*d))(kf_f, 1, 2, 0)
        y_f = kv_f * kf_f[None, :, :, :]
        y = (lambda x, s, axes=(-2,-1): torch.fft.irfft2(x, s=s, dim=axes).to(torch.bfloat16))(y_f, (1, L), axes=(1, 2))[:, 0, :S, :]
        y = y + kv * ssm_D[None, None, :]
        return q * y

    def _B_ref(x, wq, wk, wv, wo):
        B, S, D = x.shape
        H = 32
        Dh = D // H
        q = (lambda x, *d: x.permute(*d))((x @ wq).reshape(B, S, H, Dh), 0, 2, 1, 3)
        k = x @ wk
        v = x @ wv
        scores = torch.einsum("bhqd,bkd->bhqk", q, k) * (Dh ** -0.5)
        p = _softmax(scores, axis=-1)
        o = torch.einsum("bhqk,bkd->bhqd", p, v)
        return (lambda x, *d: x.permute(*d))(o, 0, 2, 1, 3).reshape(B, S, H * Dh) @ wo

    x = A_q
    g = _sigmoid((x * gate_w).sum(-1, keepdims=True))
    a = _A_ref(x, A_k, A_v, A_shift_k, A_ssm_k, A_ssm_D)
    b = _B_ref(x, B_wq, B_wk, B_wv, B_wo)
    return g * a + (1 - g) * b
```

```asm
; @launch grid=(256,1,1) block=(512,1,1) lds=163840
.amdgcn_target "amdgcn-amd-amdhsa--gfx950"
.text
.globl gated_mix__ssm_conv_h3__grouped_kv_mqa__prompt_kernel
.p2align 8
.type gated_mix__ssm_conv_h3__grouped_kv_mqa__prompt_kernel,@function
gated_mix__ssm_conv_h3__grouped_kv_mqa__prompt_kernel:
  s_cmp_ge_u32 s2, 256
  s_cbranch_scc1 gated_mix__ssm_conv_h3__grouped_kv_mqa__prompt_kernel_exit
  s_load_dwordx16 s[64:79], s[0:1], 0
  s_load_dwordx8 s[80:87], s[0:1], 64
  s_load_dwordx4 s[88:91], s[0:1], 96
  s_load_dwordx2 s[92:93], s[0:1], 112
  v_mov_b32 v6, v0
  v_and_b32 v1, 63, v0
  v_lshrrev_b32 v2, 6, v0
  s_nop 1
  v_readfirstlane_b32 s4, v2
  s_nop 4
  s_bfe_u32 s5, s2, 0x20001
  s_lshl_b32 s5, s5, 3
  s_bfe_u32 s7, s2, 0x30003
  s_add_u32 s5, s5, s7
  s_and_b32 s6, s2, 1
  s_lshl_b32 s6, s6, 2
  s_lshr_b32 s7, s2, 6
  s_add_u32 s6, s6, s7
  s_lshl_b32 s32, s6, 5
  s_add_u32 s32, s32, s5
  s_lshl_b32 s33, s4, 10
  s_lshl_b32 s34, s4, 11
  s_and_b32 s37, s6, 3
  s_lshl_b32 s37, s37, 1
  s_add_u32 s37, s37, s5
  s_lshl_b32 s37, s37, 1
  s_and_b32 s37, s37, 15
  s_mov_b32 s35, s37
  s_mov_b32 s36, s37
  s_mov_b32 s101, s37
  s_and_b32 s37, s6, 3
  v_lshrrev_b32 v2, 4, v1
  v_and_b32 v3, 15, v1
  v_add_u32 v4, 0, v2
  v_xor_b32 v5, v3, v4
  v_lshlrev_b32 v5, 4, v5
  v_lshl_add_u32 v224, v4, 11, v5
  v_add_u32 v4, 4, v2
  v_xor_b32 v5, v3, v4
  v_lshlrev_b32 v5, 4, v5
  v_lshl_add_u32 v225, v4, 11, v5
  v_add_u32 v4, 8, v2
  v_xor_b32 v5, v3, v4
  v_lshlrev_b32 v5, 4, v5
  v_lshl_add_u32 v226, v4, 11, v5
  v_add_u32 v4, 12, v2
  v_xor_b32 v5, v3, v4
  v_lshlrev_b32 v5, 4, v5
  v_lshl_add_u32 v227, v4, 11, v5
  v_lshlrev_b32 v233, 4, v1
  s_lshl_b32 s0, s5, 17
  s_lshl_b32 s7, s4, 8
  s_add_u32 s0, s0, s7
  s_lshl_b32 s35, s4, 14
  s_waitcnt lgkmcnt(0)
  s_mov_b32 s8, s64
  s_mov_b32 s9, s65
  s_mov_b32 s10, 4194304
  s_mov_b32 s11, 0x20000
  s_cmp_lt_u32 s6, 4
  s_cselect_b32 s16, s80, s82
  s_cselect_b32 s17, s81, s83
  s_mov_b32 s18, 65536
  s_mov_b32 s19, 0x20000
  s_lshl_b32 s7, s37, 15
  s_add_u32 s36, s0, s7
  s_lshl_b32 s7, s37, 12
  s_add_u32 s95, s35, s7
  s_add_u32 m0, s95, 0
  s_nop 0
  buffer_load_dwordx4 v224, s[8:11], s36 offen lds
  s_add_u32 m0, s95, 1024
  s_nop 0
  buffer_load_dwordx4 v225, s[8:11], s36 offen lds
  s_add_u32 m0, s95, 2048
  s_nop 0
  buffer_load_dwordx4 v226, s[8:11], s36 offen lds
  s_add_u32 m0, s95, 3072
  s_nop 0
  buffer_load_dwordx4 v227, s[8:11], s36 offen lds
  s_add_u32 s7, s37, 1
  s_and_b32 s7, s7, 3
  s_lshl_b32 s7, s7, 12
  s_add_u32 s33, s35, s7
  s_add_u32 s7, s37, 2
  s_and_b32 s7, s7, 3
  s_lshl_b32 s7, s7, 12
  s_add_u32 s101, s35, s7
  s_lshl_b32 s7, s4, 13
  s_add_u32 m0, s33, 0
  s_add_u32 s3, s7, 0
  buffer_load_dwordx4 v233, s[16:19], s3 offen lds
  s_add_u32 m0, s33, 1024
  s_add_u32 s3, s7, 1024
  buffer_load_dwordx4 v233, s[16:19], s3 offen lds
  s_add_u32 m0, s33, 2048
  s_add_u32 s3, s7, 2048
  buffer_load_dwordx4 v233, s[16:19], s3 offen lds
  s_add_u32 m0, s33, 3072
  s_add_u32 s3, s7, 3072
  buffer_load_dwordx4 v233, s[16:19], s3 offen lds
  s_add_u32 m0, s101, 0
  s_add_u32 s3, s7, 4096
  buffer_load_dwordx4 v233, s[16:19], s3 offen lds
  s_add_u32 m0, s101, 1024
  s_add_u32 s3, s7, 5120
  buffer_load_dwordx4 v233, s[16:19], s3 offen lds
  s_add_u32 m0, s101, 2048
  s_add_u32 s3, s7, 6144
  buffer_load_dwordx4 v233, s[16:19], s3 offen lds
  s_add_u32 m0, s101, 3072
  s_add_u32 s3, s7, 7168
  buffer_load_dwordx4 v233, s[16:19], s3 offen lds
  s_mov_b32 s20, s86
  s_mov_b32 s21, s87
  s_mov_b32 s22, 2048
  s_mov_b32 s23, 0x20000
  v_lshlrev_b32 v2, 2, v1
  s_lshl_b32 s7, s4, 8
  buffer_load_dword v230, v2, s[20:23], s7 offen
  s_mov_b32 s20, s66
  s_mov_b32 s21, s67
  s_mov_b32 s22, 4194304
  s_mov_b32 s23, 0x20000
  s_mov_b32 s24, s68
  s_mov_b32 s25, s69
  s_mov_b32 s26, 4194304
  s_mov_b32 s27, 0x20000
  s_mov_b32 s60, s70
  s_mov_b32 s61, s71
  s_mov_b32 s62, 8192
  s_mov_b32 s63, 0x20000
  s_lshl_b32 s7, s5, 6
  s_lshl_b32 s3, s4, 3
  s_add_u32 s7, s7, s3
  s_lshl_b32 s7, s7, 11
  s_lshl_b32 s3, s6, 8
  s_add_u32 s7, s7, s3
  v_lshlrev_b32 v4, 2, v1
  v_add_u32 v231, s7, v4
  v_lshlrev_b32 v5, 2, v4
  s_mov_b32 s12, s78
  s_mov_b32 s13, s79
  s_mov_b32 s14, 2097152
  s_mov_b32 s15, 0x20000
  s_lshr_b32 s7, s2, 3
  s_and_b32 s7, s7, 31
  s_lshl_b32 s7, s7, 16
  s_lshl_b32 s3, s4, 13
  s_add_u32 s7, s7, s3
  s_and_b32 s3, s2, 1
  s_lshl_b32 s3, s3, 10
  s_add_u32 s7, s7, s3
  v_and_b32 v2, 7, v1
  v_lshlrev_b32 v2, 7, v2
  v_bfe_u32 v3, v1, 3, 2
  v_lshl_add_u32 v2, v3, 11, v2
  s_mov_b32 exec_hi, 0
  buffer_load_dword v232, v2, s[12:15], s7 offen
  s_mov_b32 exec_hi, -1
  s_lshl_b32 s38, s6, 10
  v_lshlrev_b32 v5, 4, v1
  buffer_load_dwordx4 v[212:215], v5, s[60:63], s38 offen
  v_add_u32 v4, 4294961152, v231
  buffer_load_dword v200, v4, s[20:23], 0 offen
  v_add_u32 v4, 4294963200, v231
  buffer_load_dword v201, v4, s[20:23], 0 offen
  v_add_u32 v4, 4294965248, v231
  buffer_load_dword v202, v4, s[20:23], 0 offen
  s_movk_i32 s38, 0
  buffer_load_dword v203, v231, s[20:23], s38 offen
  s_movk_i32 s38, 2048
  buffer_load_dword v204, v231, s[20:23], s38 offen
  s_movk_i32 s38, 4096
  buffer_load_dword v205, v231, s[20:23], s38 offen
  s_movk_i32 s38, 6144
  buffer_load_dword v206, v231, s[20:23], s38 offen
  s_movk_i32 s38, 8192
  buffer_load_dword v207, v231, s[20:23], s38 offen
  s_movk_i32 s38, 10240
  buffer_load_dword v208, v231, s[20:23], s38 offen
  s_movk_i32 s38, 12288
  buffer_load_dword v209, v231, s[20:23], s38 offen
  s_movk_i32 s38, 14336
  buffer_load_dword v210, v231, s[20:23], s38 offen
  s_movk_i32 s38, 0
  buffer_load_dword v12, v231, s[24:27], s38 offen
  s_movk_i32 s38, 2048
  buffer_load_dword v13, v231, s[24:27], s38 offen
  s_movk_i32 s38, 4096
  buffer_load_dword v14, v231, s[24:27], s38 offen
  s_movk_i32 s38, 6144
  buffer_load_dword v15, v231, s[24:27], s38 offen
  s_movk_i32 s38, 8192
  buffer_load_dword v16, v231, s[24:27], s38 offen
  s_movk_i32 s38, 10240
  buffer_load_dword v17, v231, s[24:27], s38 offen
  s_movk_i32 s38, 12288
  buffer_load_dword v18, v231, s[24:27], s38 offen
  s_movk_i32 s38, 14336
  buffer_load_dword v19, v231, s[24:27], s38 offen
  s_mov_b32 s28, s92
  s_mov_b32 s29, s93
  s_mov_b32 s30, 268435456
  s_mov_b32 s31, 0x20000
  s_mov_b32 s96, s90
  s_mov_b32 s97, s91
  s_mov_b32 s98, 256
  s_mov_b32 s99, 0x20000
  s_or_b32 s7, s2, s4
  s_cmp_lg_u32 s7, 0
  s_cbranch_scc1 nonce_1
  s_memrealtime s[38:39]
  s_waitcnt lgkmcnt(0)
  s_or_b32 s38, s38, 1
  v_mov_b32 v3, s38
  v_mov_b32 v2, 0
  s_mov_b64 exec, 1
  buffer_store_dword v3, v2, s[96:99], 0 offen sc1
  s_mov_b64 exec, -1
nonce_1:
  s_lshl_b32 s7, s32, 2
  s_lshr_b32 s3, s4, 1
  s_add_u32 s7, s7, s3
  s_lshl_b32 s7, s7, 1
  s_and_b32 s7, s7, 0xfffffffc
  s_load_dword s94, s[74:75], s7
  v_and_b32 v2, 15, v1
  v_lshrrev_b32 v3, 4, v1
  v_xor_b32 v3, v3, v2
  v_lshlrev_b32 v3, 4, v3
  v_lshl_add_u32 v2, v2, 8, v3
  v_add_u32 v233, s95, v2
  v_xor_b32 v234, 64, v233
  v_xor_b32 v235, 128, v233
  v_xor_b32 v236, 192, v233
  v_lshrrev_b32 v2, 4, v1
  v_lshlrev_b32 v2, 3, v2
  v_bfe_u32 v3, v1, 2, 2
  v_add_u32 v2, v2, v3
  v_and_b32 v3, 3, v1
  v_lshlrev_b32 v3, 3, v3
  v_lshl_add_u32 v3, v2, 6, v3
  v_add_u32 v237, s33, v3
  v_add_u32 v238, s101, v3
  s_lshl_b32 s7, s4, 10
  s_add_u32 s7, s7, 131072
  v_lshlrev_b32 v2, 3, v2
  v_add_u32 v239, s7, v2
  v_mov_b32 v52, 0
  v_mov_b32 v53, 0
  v_mov_b32 v54, 0
  v_mov_b32 v55, 0
  v_mov_b32 v56, 0
  v_mov_b32 v57, 0
  v_mov_b32 v58, 0
  v_mov_b32 v59, 0
  v_mov_b32 v60, 0
  v_mov_b32 v61, 0
  v_mov_b32 v62, 0
  v_mov_b32 v63, 0
  s_waitcnt vmcnt(21)
  v_lshlrev_b32 v2, 4, v1
  v_add_u32 v2, s7, v2
  v_and_b32 v3, 0xffff, v230
  v_lshrrev_b32 v4, 16, v230
  ds_write_b32 v2, v3
  ds_write_b32 v2, v4 offset:8
  s_waitcnt lgkmcnt(0)
  ds_read_b128 v[20:23], v233
  ds_read_b64_tr_b16 v[64:65], v237 offset:0
  ds_read_b64_tr_b16 v[66:67], v237 offset:256
  ds_read_b64_tr_b16 v[68:69], v237 offset:32
  ds_read_b64_tr_b16 v[70:71], v237 offset:288
  ds_read_b64_tr_b16 v[72:73], v239 offset:0
  ds_read_b64_tr_b16 v[74:75], v239 offset:32
  ds_read_b128 v[24:27], v234
  ds_read_b64_tr_b16 v[76:77], v237 offset:2048
  ds_read_b64_tr_b16 v[78:79], v237 offset:2304
  ds_read_b64_tr_b16 v[80:81], v237 offset:2080
  ds_read_b64_tr_b16 v[82:83], v237 offset:2336
  ds_read_b64_tr_b16 v[84:85], v239 offset:256
  ds_read_b64_tr_b16 v[86:87], v239 offset:288
  s_waitcnt lgkmcnt(0)
  ds_read_b128 v[28:31], v235
  ds_read_b64_tr_b16 v[88:89], v238 offset:0
  ds_read_b64_tr_b16 v[90:91], v238 offset:256
  ds_read_b64_tr_b16 v[92:93], v238 offset:32
  ds_read_b64_tr_b16 v[94:95], v238 offset:288
  ds_read_b64_tr_b16 v[96:97], v239 offset:512
  ds_read_b64_tr_b16 v[98:99], v239 offset:544
  ds_read_b128 v[32:35], v236
  ds_read_b64_tr_b16 v[100:101], v238 offset:2048
  ds_read_b64_tr_b16 v[102:103], v238 offset:2304
  ds_read_b64_tr_b16 v[104:105], v238 offset:2080
  ds_read_b64_tr_b16 v[106:107], v238 offset:2336
  ds_read_b64_tr_b16 v[108:109], v239 offset:768
  ds_read_b64_tr_b16 v[110:111], v239 offset:800
  s_waitcnt lgkmcnt(0)
  s_cmp_ge_u32 s6, 4
  s_cbranch_scc1 kvv_2
  v_mfma_f32_16x16x32_bf16 v[52:55], v[64:67], v[20:23], v[52:55]
  v_mfma_f32_16x16x32_bf16 v[56:59], v[68:71], v[20:23], v[56:59]
  v_mfma_f32_16x16x32_bf16 v[60:63], v[72:75], v[20:23], v[60:63]
  v_mfma_f32_16x16x32_bf16 v[52:55], v[76:79], v[24:27], v[52:55]
  v_mfma_f32_16x16x32_bf16 v[56:59], v[80:83], v[24:27], v[56:59]
  v_mfma_f32_16x16x32_bf16 v[60:63], v[84:87], v[24:27], v[60:63]
  v_mfma_f32_16x16x32_bf16 v[52:55], v[88:91], v[28:31], v[52:55]
  v_mfma_f32_16x16x32_bf16 v[56:59], v[92:95], v[28:31], v[56:59]
  v_mfma_f32_16x16x32_bf16 v[60:63], v[96:99], v[28:31], v[60:63]
  v_mfma_f32_16x16x32_bf16 v[52:55], v[100:103], v[32:35], v[52:55]
  v_mfma_f32_16x16x32_bf16 v[56:59], v[104:107], v[32:35], v[56:59]
  v_mfma_f32_16x16x32_bf16 v[60:63], v[108:111], v[32:35], v[60:63]
  s_branch kvr_3
kvv_2:
  v_mfma_f32_16x16x32_bf16 v[52:55], v[20:23], v[64:67], v[52:55]
  v_mfma_f32_16x16x32_bf16 v[56:59], v[20:23], v[68:71], v[56:59]
  v_mfma_f32_16x16x32_bf16 v[60:63], v[20:23], v[72:75], v[60:63]
  v_mfma_f32_16x16x32_bf16 v[52:55], v[24:27], v[76:79], v[52:55]
  v_mfma_f32_16x16x32_bf16 v[56:59], v[24:27], v[80:83], v[56:59]
  v_mfma_f32_16x16x32_bf16 v[60:63], v[24:27], v[84:87], v[60:63]
  v_mfma_f32_16x16x32_bf16 v[52:55], v[28:31], v[88:91], v[52:55]
  v_mfma_f32_16x16x32_bf16 v[56:59], v[28:31], v[92:95], v[56:59]
  v_mfma_f32_16x16x32_bf16 v[60:63], v[28:31], v[96:99], v[60:63]
  v_mfma_f32_16x16x32_bf16 v[52:55], v[32:35], v[100:103], v[52:55]
  v_mfma_f32_16x16x32_bf16 v[56:59], v[32:35], v[104:107], v[56:59]
  v_mfma_f32_16x16x32_bf16 v[60:63], v[32:35], v[108:111], v[60:63]
kvr_3:
  s_mul_i32 s7, s4, 3072
  s_add_u32 s7, s7, 139264
  v_lshlrev_b32 v2, 4, v1
  v_add_u32 v3, s7, v2
  s_nop 5
  ds_write_b128 v3, v[52:55] offset:0
  ds_write_b128 v3, v[56:59] offset:1024
  ds_write_b128 v3, v[60:63] offset:2048
  s_waitcnt lgkmcnt(0)
  s_barrier
  s_cmp_ge_u32 s4, 3
  s_cbranch_scc1 kve_4
  s_lshl_b32 s7, s4, 10
  s_add_u32 s7, s7, 139264
  v_lshlrev_b32 v2, 4, v1
  v_add_u32 v3, s7, v2
  ds_read_b128 v[64:67], v3 offset:0
  ds_read_b128 v[68:71], v3 offset:3072
  ds_read_b128 v[72:75], v3 offset:6144
  ds_read_b128 v[76:79], v3 offset:9216
  ds_read_b128 v[80:83], v3 offset:12288
  ds_read_b128 v[84:87], v3 offset:15360
  ds_read_b128 v[88:91], v3 offset:18432
  ds_read_b128 v[92:95], v3 offset:21504
  s_waitcnt lgkmcnt(0)
  v_add_f32 v64, v64, v80
  v_add_f32 v65, v65, v81
  v_add_f32 v66, v66, v82
  v_add_f32 v67, v67, v83
  v_add_f32 v68, v68, v84
  v_add_f32 v69, v69, v85
  v_add_f32 v70, v70, v86
  v_add_f32 v71, v71, v87
  v_add_f32 v72, v72, v88
  v_add_f32 v73, v73, v89
  v_add_f32 v74, v74, v90
  v_add_f32 v75, v75, v91
  v_add_f32 v76, v76, v92
  v_add_f32 v77, v77, v93
  v_add_f32 v78, v78, v94
  v_add_f32 v79, v79, v95
  v_add_f32 v64, v64, v72
  v_add_f32 v65, v65, v73
  v_add_f32 v66, v66, v74
  v_add_f32 v67, v67, v75
  v_add_f32 v68, v68, v76
  v_add_f32 v69, v69, v77
  v_add_f32 v70, v70, v78
  v_add_f32 v71, v71, v79
  v_add_f32 v64, v64, v68
  v_add_f32 v65, v65, v69
  v_add_f32 v66, v66, v70
  v_add_f32 v67, v67, v71
  s_cmp_eq_u32 s4, 2
  s_cbranch_scc1 kvg_7
  v_cvt_pk_bf16_f32 v68, v64, v65
  v_cvt_pk_bf16_f32 v69, v66, v67
  v_mov_b32 v70, v68
  v_mov_b32 v71, v69
  s_nop 1
  v_permlane16_swap_b32 v68, v70
  v_permlane16_swap_b32 v69, v71
  s_mov_b32 s38, 0xffff
  s_mov_b32 s39, 0xffff
  s_cmp_ge_u32 s6, 4
  s_cbranch_scc1 kv2_5
  s_and_b32 s7, s37, 1
  s_lshl_b32 s7, s7, 4
  v_and_b32 v2, 15, v1
  v_add_u32 v2, s7, v2
  v_and_b32 v3, 0x13, v2
  v_bfe_u32 v4, v2, 2, 1
  v_lshl_or_b32 v3, v4, 3, v3
  v_bfe_u32 v4, v2, 3, 1
  v_lshl_or_b32 v3, v4, 2, v3
  v_lshlrev_b32 v3, 4, v3
  v_lshrrev_b32 v2, 5, v1
  v_lshl_add_u32 v2, v2, 9, v3
  s_lshl_b32 s3, s4, 10
  s_mov_b32 s7, 16777216
  s_branch kvs_6
kv2_5:
  s_lshl_b32 s7, s4, 4
  v_and_b32 v2, 15, v1
  v_add_u32 v2, s7, v2
  v_and_b32 v3, 3, v2
  v_bfe_u32 v4, v2, 2, 2
  v_lshl_or_b32 v3, v4, 3, v3
  v_bfe_u32 v4, v2, 4, 1
  v_lshl_or_b32 v3, v4, 2, v3
  v_lshlrev_b32 v3, 4, v3
  v_lshrrev_b32 v2, 5, v1
  v_lshl_add_u32 v2, v2, 9, v3
  s_and_b32 s3, s37, 1
  s_lshl_b32 s3, s3, 10
  s_mov_b32 s7, 16779264
kvs_6:
  s_add_u32 s7, s7, s3
  s_lshl_b32 s3, s5, 13
  s_add_u32 s7, s7, s3
  s_lshr_b32 s3, s37, 1
  s_lshl_b32 s3, s3, 12
  s_add_u32 s7, s7, s3
  s_mov_b64 exec, s[38:39]
  buffer_store_dwordx4 v[68:71], v2, s[28:31], s7 offen sc1
  s_mov_b64 exec, -1
  s_branch kve_4
kvg_7:
  s_cmp_ge_u32 s6, 4
  s_cbranch_scc1 kve_4
  s_lshl_b32 s7, s5, 8
  s_lshl_b32 s3, s37, 6
  s_add_u32 s7, s7, s3
  s_add_u32 s7, s7, 17039360
  v_lshlrev_b32 v2, 2, v1
  s_mov_b64 exec, 0xffff
  buffer_store_dword v64, v2, s[28:31], s7 offen sc1
  s_mov_b64 exec, -1
kve_4:
  s_add_u32 s7, s37, 1
  s_and_b32 s7, s7, 3
  s_lshl_b32 s3, s7, 15
  s_add_u32 s36, s0, s3
  s_lshl_b32 s3, s7, 12
  s_add_u32 s95, s35, s3
  s_add_u32 m0, s95, 0
  s_nop 0
  buffer_load_dwordx4 v224, s[8:11], s36 offen lds
  s_add_u32 m0, s95, 1024
  s_nop 0
  buffer_load_dwordx4 v225, s[8:11], s36 offen lds
  s_add_u32 m0, s95, 2048
  s_nop 0
  buffer_load_dwordx4 v226, s[8:11], s36 offen lds
  s_add_u32 m0, s95, 3072
  s_nop 0
  buffer_load_dwordx4 v227, s[8:11], s36 offen lds
  s_add_u32 s7, s37, 2
  s_and_b32 s7, s7, 3
  s_lshl_b32 s3, s7, 15
  s_add_u32 s36, s0, s3
  s_lshl_b32 s3, s7, 12
  s_add_u32 s95, s35, s3
  s_add_u32 m0, s95, 0
  s_nop 0
  buffer_load_dwordx4 v224, s[8:11], s36 offen lds
  s_add_u32 m0, s95, 1024
  s_nop 0
  buffer_load_dwordx4 v225, s[8:11], s36 offen lds
  s_add_u32 m0, s95, 2048
  s_nop 0
  buffer_load_dwordx4 v226, s[8:11], s36 offen lds
  s_add_u32 m0, s95, 3072
  s_nop 0
  buffer_load_dwordx4 v227, s[8:11], s36 offen lds
  s_add_u32 s7, s37, 3
  s_and_b32 s7, s7, 3
  s_lshl_b32 s3, s7, 15
  s_add_u32 s36, s0, s3
  s_lshl_b32 s3, s7, 12
  s_add_u32 s95, s35, s3
  s_add_u32 m0, s95, 0
  s_nop 0
  buffer_load_dwordx4 v224, s[8:11], s36 offen lds
  s_add_u32 m0, s95, 1024
  s_nop 0
  buffer_load_dwordx4 v225, s[8:11], s36 offen lds
  s_add_u32 m0, s95, 2048
  s_nop 0
  buffer_load_dwordx4 v226, s[8:11], s36 offen lds
  s_add_u32 m0, s95, 3072
  s_nop 0
  buffer_load_dwordx4 v227, s[8:11], s36 offen lds
  v_mov_b32 v232, 0
  buffer_load_dword v232, v232, s[96:99], 0 offen sc1
  v_and_b32 v2, 31, v1
  v_and_b32 v3, 15, v1
  v_lshrrev_b32 v4, 5, v1
  v_xor_b32 v3, v3, v4
  v_lshlrev_b32 v3, 4, v3
  v_lshl_add_u32 v2, v2, 8, v3
  s_and_b32 s7, s4, 1
  s_lshl_b32 s7, s7, 16
  v_add_u32 v2, s7, v2
  v_xor_b32 v216, 0, v2
  v_xor_b32 v217, 32, v2
  v_xor_b32 v218, 64, v2
  v_xor_b32 v219, 96, v2
  v_xor_b32 v220, 128, v2
  v_xor_b32 v221, 160, v2
  v_xor_b32 v222, 192, v2
  v_xor_b32 v223, 224, v2
  v_and_b32 v2, 3, v1
  v_and_b32 v3, 1, v2
  v_lshlrev_b32 v3, 1, v3
  v_lshrrev_b32 v2, 1, v2
  v_or_b32 v2, v2, v3
  v_lshlrev_b32 v2, 3, v2
  v_bfe_u32 v3, v1, 4, 1
  v_lshl_add_u32 v2, v3, 5, v2
  v_bfe_u32 v3, v1, 2, 2
  v_lshrrev_b32 v4, 5, v1
  v_lshl_add_u32 v3, v4, 3, v3
  v_lshl_add_u32 v2, v3, 6, v2
  s_lshl_b32 s35, s4, 12
  s_add_u32 s35, s35, 131072
  v_add_u32 v228, s35, v2
  v_lshrrev_b32 v2, 2, v1
  v_and_b32 v3, 3, v1
  v_lshlrev_b32 v3, 4, v3
  v_lshl_add_u32 v2, v2, 11, v3
  s_lshl_b32 s7, s6, 8
  s_lshr_b32 s3, s4, 1
  s_lshl_b32 s3, s3, 6
  s_add_u32 s7, s7, s3
  v_add_u32 v229, s7, v2
  s_and_b32 s36, s4, 1
  s_lshl_b32 s36, s36, 20
  v_mov_b32 v20, 0
  v_mov_b32 v21, 0
  v_mov_b32 v22, 0
  v_mov_b32 v23, 0
  v_mov_b32 v24, 0
  v_mov_b32 v25, 0
  v_mov_b32 v26, 0
  v_mov_b32 v27, 0
  v_mov_b32 v28, 0
  v_mov_b32 v29, 0
  v_mov_b32 v30, 0
  v_mov_b32 v31, 0
  v_mov_b32 v32, 0
  v_mov_b32 v33, 0
  v_mov_b32 v34, 0
  v_mov_b32 v35, 0
  v_mov_b32 v36, 0
  v_mov_b32 v37, 0
  v_mov_b32 v38, 0
  v_mov_b32 v39, 0
  v_mov_b32 v40, 0
  v_mov_b32 v41, 0
  v_mov_b32 v42, 0
  v_mov_b32 v43, 0
  v_mov_b32 v44, 0
  v_mov_b32 v45, 0
  v_mov_b32 v46, 0
  v_mov_b32 v47, 0
  v_mov_b32 v48, 0
  v_mov_b32 v49, 0
  v_mov_b32 v50, 0
  v_mov_b32 v51, 0
  s_barrier
  s_add_u32 m0, s35, 0
  s_add_u32 s3, s36, 0
  buffer_load_dwordx4 v229, s[12:15], s3 offen lds
  s_add_u32 m0, s35, 1024
  s_add_u32 s3, s36, 32768
  buffer_load_dwordx4 v229, s[12:15], s3 offen lds
  s_add_u32 m0, s35, 2048
  s_add_u32 s3, s36, 65536
  buffer_load_dwordx4 v229, s[12:15], s3 offen lds
  s_add_u32 m0, s35, 3072
  s_add_u32 s3, s36, 98304
  buffer_load_dwordx4 v229, s[12:15], s3 offen lds
  s_waitcnt vmcnt(3)
  v_readfirstlane_b32 s100, v232
  s_nop 3
  s_cmp_lg_u32 s100, 0
  s_cbranch_scc1 kvg_9
  s_mov_b32 s3, 0
  v_mov_b32 v2, 0
tgp_11:
  buffer_load_dword v3, v2, s[96:99], 0 offen sc1
  s_waitcnt vmcnt(0)
  v_readfirstlane_b32 s100, v3
  s_nop 4
  s_cmp_lg_u32 s100, 0
  s_cbranch_scc1 tg_10
  s_add_u32 s3, s3, 1
  s_cmp_lt_u32 s3, 200000
  s_sleep 1
  s_cbranch_scc1 tgp_11
tg_10:
kvg_9:
  s_cmp_ge_u32 s4, 4
  s_cbranch_scc1 kvf_8
  s_lshl_b32 s7, s32, 6
  s_lshl_b32 s38, s4, 2
  s_add_u32 s7, s7, s38
  s_add_u32 s7, s7, 17825792
  v_mov_b32 v2, 0
  v_mov_b32 v3, s100
  s_mov_b64 exec, 1
  buffer_store_dword v3, v2, s[28:31], s7 offen sc1
  s_mov_b64 exec, -1
kvf_8:
  s_barrier
  ds_read_b128 v[144:147], v216 offset:0
  ds_read_b128 v[148:151], v216 offset:8192
  ds_read_b128 v[152:155], v217 offset:0
  ds_read_b128 v[156:159], v217 offset:8192
  ds_read_b64_tr_b16 v[64:65], v228 offset:0
  ds_read_b64_tr_b16 v[66:67], v228 offset:256
  s_waitcnt vmcnt(2)
  s_waitcnt lgkmcnt(0)
  v_mfma_f32_32x32x16_bf16 v[20:35], v[64:67], v[144:147], v[20:35]
  ds_read_b64_tr_b16 v[68:69], v228 offset:1024
  ds_read_b64_tr_b16 v[70:71], v228 offset:1280
  ds_read_b128 v[160:163], v218 offset:0
  ds_read_b128 v[164:167], v218 offset:8192
  v_mfma_f32_32x32x16_bf16 v[36:51], v[64:67], v[148:151], v[36:51]
  s_add_u32 m0, s35, 0
  s_add_u32 s3, s36, 131072
  buffer_load_dwordx4 v229, s[12:15], s3 offen lds
  v_lshlrev_b32 v128, 16, v212
  v_and_b32 v129, 0xffff0000, v212
  v_lshlrev_b32 v130, 16, v213
  v_and_b32 v131, 0xffff0000, v213
  v_lshlrev_b32 v132, 16, v214
  s_waitcnt vmcnt(2)
  s_waitcnt lgkmcnt(2)
  v_mfma_f32_32x32x16_bf16 v[20:35], v[68:71], v[152:155], v[20:35]
  ds_read_b64_tr_b16 v[64:65], v228 offset:2048
  ds_read_b64_tr_b16 v[66:67], v228 offset:2304
  ds_read_b128 v[144:147], v219 offset:0
  ds_read_b128 v[148:151], v219 offset:8192
  v_mfma_f32_32x32x16_bf16 v[36:51], v[68:71], v[156:159], v[36:51]
  s_add_u32 m0, s35, 1024
  s_add_u32 s3, s36, 163840
  buffer_load_dwordx4 v229, s[12:15], s3 offen lds
  v_and_b32 v133, 0xffff0000, v214
  v_lshlrev_b32 v134, 16, v215
  v_and_b32 v135, 0xffff0000, v215
  v_lshlrev_b32 v104, 16, v200
  v_and_b32 v105, 0xffff0000, v200
  s_waitcnt vmcnt(2)
  s_waitcnt lgkmcnt(2)
  v_mfma_f32_32x32x16_bf16 v[20:35], v[64:67], v[160:163], v[20:35]
  ds_read_b64_tr_b16 v[68:69], v228 offset:3072
  ds_read_b64_tr_b16 v[70:71], v228 offset:3328
  ds_read_b128 v[152:155], v220 offset:0
  ds_read_b128 v[156:159], v220 offset:8192
  v_mfma_f32_32x32x16_bf16 v[36:51], v[64:67], v[164:167], v[36:51]
  s_add_u32 m0, s35, 2048
  s_add_u32 s3, s36, 196608
  buffer_load_dwordx4 v229, s[12:15], s3 offen lds
  v_lshlrev_b32 v106, 16, v201
  v_and_b32 v107, 0xffff0000, v201
  v_lshlrev_b32 v108, 16, v202
  v_and_b32 v109, 0xffff0000, v202
  v_lshlrev_b32 v110, 16, v203
  s_waitcnt vmcnt(2)
  s_waitcnt lgkmcnt(2)
  v_mfma_f32_32x32x16_bf16 v[20:35], v[68:71], v[144:147], v[20:35]
  ds_read_b64_tr_b16 v[64:65], v228 offset:0
  ds_read_b64_tr_b16 v[66:67], v228 offset:256
  ds_read_b128 v[160:163], v221 offset:0
  ds_read_b128 v[164:167], v221 offset:8192
  v_mfma_f32_32x32x16_bf16 v[36:51], v[68:71], v[148:151], v[36:51]
  s_add_u32 m0, s35, 3072
  s_add_u32 s3, s36, 229376
  buffer_load_dwordx4 v229, s[12:15], s3 offen lds
  v_and_b32 v111, 0xffff0000, v203
  v_lshlrev_b32 v112, 16, v204
  v_and_b32 v113, 0xffff0000, v204
  v_lshlrev_b32 v114, 16, v205
  v_and_b32 v115, 0xffff0000, v205
  s_waitcnt vmcnt(2)
  s_waitcnt lgkmcnt(2)
  v_mfma_f32_32x32x16_bf16 v[20:35], v[64:67], v[152:155], v[20:35]
  ds_read_b64_tr_b16 v[68:69], v228 offset:1024
  ds_read_b64_tr_b16 v[70:71], v228 offset:1280
  ds_read_b128 v[144:147], v222 offset:0
  ds_read_b128 v[148:151], v222 offset:8192
  v_mfma_f32_32x32x16_bf16 v[36:51], v[64:67], v[156:159], v[36:51]
  s_add_u32 m0, s35, 0
  s_add_u32 s3, s36, 262144
  buffer_load_dwordx4 v229, s[12:15], s3 offen lds
  v_lshlrev_b32 v116, 16, v206
  v_and_b32 v117, 0xffff0000, v206
  v_lshlrev_b32 v118, 16, v207
  v_and_b32 v119, 0xffff0000, v207
  v_lshlrev_b32 v120, 16, v208
  s_waitcnt vmcnt(2)
  s_waitcnt lgkmcnt(2)
  v_mfma_f32_32x32x16_bf16 v[20:35], v[68:71], v[160:163], v[20:35]
  ds_read_b64_tr_b16 v[64:65], v228 offset:2048
  ds_read_b64_tr_b16 v[66:67], v228 offset:2304
  ds_read_b128 v[152:155], v223 offset:0
  ds_read_b128 v[156:159], v223 offset:8192
  v_mfma_f32_32x32x16_bf16 v[36:51], v[68:71], v[164:167], v[36:51]
  s_add_u32 m0, s35, 1024
  s_add_u32 s3, s36, 294912
  buffer_load_dwordx4 v229, s[12:15], s3 offen lds
  v_and_b32 v121, 0xffff0000, v208
  v_lshlrev_b32 v122, 16, v209
  v_and_b32 v123, 0xffff0000, v209
  v_lshlrev_b32 v124, 16, v210
  v_and_b32 v125, 0xffff0000, v210
  s_waitcnt vmcnt(2)
  s_waitcnt lgkmcnt(2)
  v_mfma_f32_32x32x16_bf16 v[20:35], v[64:67], v[144:147], v[20:35]
  ds_read_b64_tr_b16 v[68:69], v228 offset:3072
  ds_read_b64_tr_b16 v[70:71], v228 offset:3328
  ds_read_b128 v[160:163], v216 offset:16384
  ds_read_b128 v[164:167], v216 offset:24576
  v_mfma_f32_32x32x16_bf16 v[36:51], v[64:67], v[148:151], v[36:51]
  s_add_u32 m0, s35, 2048
  s_add_u32 s3, s36, 327680
  buffer_load_dwordx4 v229, s[12:15], s3 offen lds
  v_mul_f32 v88, v110, v128
  v_fma_f32 v88, v108, v129, v88
  v_fma_f32 v88, v106, v130, v88
  v_fma_f32 v88, v104, v131, v88
  v_mul_f32 v89, v111, v132
  s_waitcnt vmcnt(2)
  s_waitcnt lgkmcnt(2)
  v_mfma_f32_32x32x16_bf16 v[20:35], v[68:71], v[152:155], v[20:35]
  ds_read_b64_tr_b16 v[64:65], v228 offset:0
  ds_read_b64_tr_b16 v[66:67], v228 offset:256
  ds_read_b128 v[144:147], v217 offset:16384
  ds_read_b128 v[148:151], v217 offset:24576
  v_mfma_f32_32x32x16_bf16 v[36:51], v[68:71], v[156:159], v[36:51]
  s_add_u32 m0, s35, 3072
  s_add_u32 s3, s36, 360448
  buffer_load_dwordx4 v229, s[12:15], s3 offen lds
  v_fma_f32 v89, v109, v133, v89
  v_fma_f32 v89, v107, v134, v89
  v_fma_f32 v89, v105, v135, v89
  v_mul_f32 v90, v112, v128
  v_fma_f32 v90, v110, v129, v90
  s_waitcnt vmcnt(2)
  s_waitcnt lgkmcnt(2)
  v_mfma_f32_32x32x16_bf16 v[20:35], v[64:67], v[160:163], v[20:35]
  ds_read_b64_tr_b16 v[68:69], v228 offset:1024
  ds_read_b64_tr_b16 v[70:71], v228 offset:1280
  ds_read_b128 v[152:155], v218 offset:16384
  ds_read_b128 v[156:159], v218 offset:24576
  v_mfma_f32_32x32x16_bf16 v[36:51], v[64:67], v[164:167], v[36:51]
  s_add_u32 m0, s35, 0
  s_add_u32 s3, s36, 393216
  buffer_load_dwordx4 v229, s[12:15], s3 offen lds
  v_fma_f32 v90, v108, v130, v90
  v_fma_f32 v90, v106, v131, v90
  v_mul_f32 v91, v113, v132
  v_fma_f32 v91, v111, v133, v91
  v_fma_f32 v91, v109, v134, v91
  s_waitcnt vmcnt(2)
  s_waitcnt lgkmcnt(2)
  v_mfma_f32_32x32x16_bf16 v[20:35], v[68:71], v[144:147], v[20:35]
  ds_read_b64_tr_b16 v[64:65], v228 offset:2048
  ds_read_b64_tr_b16 v[66:67], v228 offset:2304
  ds_read_b128 v[160:163], v219 offset:16384
  ds_read_b128 v[164:167], v219 offset:24576
  v_mfma_f32_32x32x16_bf16 v[36:51], v[68:71], v[148:151], v[36:51]
  s_add_u32 m0, s35, 1024
  s_add_u32 s3, s36, 425984
  buffer_load_dwordx4 v229, s[12:15], s3 offen lds
  v_fma_f32 v91, v107, v135, v91
  v_mul_f32 v92, v114, v128
  v_fma_f32 v92, v112, v129, v92
  v_fma_f32 v92, v110, v130, v92
  v_fma_f32 v92, v108, v131, v92
  s_waitcnt vmcnt(2)
  s_waitcnt lgkmcnt(2)
  v_mfma_f32_32x32x16_bf16 v[20:35], v[64:67], v[152:155], v[20:35]
  ds_read_b64_tr_b16 v[68:69], v228 offset:3072
  ds_read_b64_tr_b16 v[70:71], v228 offset:3328
  ds_read_b128 v[144:147], v220 offset:16384
  ds_read_b128 v[148:151], v220 offset:24576
  v_mfma_f32_32x32x16_bf16 v[36:51], v[64:67], v[156:159], v[36:51]
  s_add_u32 m0, s35, 2048
  s_add_u32 s3, s36, 458752
  buffer_load_dwordx4 v229, s[12:15], s3 offen lds
  v_mul_f32 v93, v115, v132
  v_fma_f32 v93, v113, v133, v93
  v_fma_f32 v93, v111, v134, v93
  v_fma_f32 v93, v109, v135, v93
  v_mul_f32 v94, v116, v128
  s_waitcnt vmcnt(2)
  s_waitcnt lgkmcnt(2)
  v_mfma_f32_32x32x16_bf16 v[20:35], v[68:71], v[160:163], v[20:35]
  ds_read_b64_tr_b16 v[64:65], v228 offset:0
  ds_read_b64_tr_b16 v[66:67], v228 offset:256
  ds_read_b128 v[152:155], v221 offset:16384
  ds_read_b128 v[156:159], v221 offset:24576
  v_mfma_f32_32x32x16_bf16 v[36:51], v[68:71], v[164:167], v[36:51]
  s_add_u32 m0, s35, 3072
  s_add_u32 s3, s36, 491520
  buffer_load_dwordx4 v229, s[12:15], s3 offen lds
  v_fma_f32 v94, v114, v129, v94
  v_fma_f32 v94, v112, v130, v94
  v_fma_f32 v94, v110, v131, v94
  v_mul_f32 v95, v117, v132
  v_fma_f32 v95, v115, v133, v95
  s_waitcnt vmcnt(2)
  s_waitcnt lgkmcnt(2)
  v_mfma_f32_32x32x16_bf16 v[20:35], v[64:67], v[144:147], v[20:35]
  ds_read_b64_tr_b16 v[68:69], v228 offset:1024
  ds_read_b64_tr_b16 v[70:71], v228 offset:1280
  ds_read_b128 v[160:163], v222 offset:16384
  ds_read_b128 v[164:167], v222 offset:24576
  v_mfma_f32_32x32x16_bf16 v[36:51], v[64:67], v[148:151], v[36:51]
  s_add_u32 m0, s35, 0
  s_add_u32 s3, s36, 524288
  buffer_load_dwordx4 v229, s[12:15], s3 offen lds
  v_fma_f32 v95, v113, v134, v95
  v_fma_f32 v95, v111, v135, v95
  v_mul_f32 v96, v118, v128
  v_fma_f32 v96, v116, v129, v96
  v_fma_f32 v96, v114, v130, v96
  s_waitcnt vmcnt(2)
  s_waitcnt lgkmcnt(2)
  v_mfma_f32_32x32x16_bf16 v[20:35], v[68:71], v[152:155], v[20:35]
  ds_read_b64_tr_b16 v[64:65], v228 offset:2048
  ds_read_b64_tr_b16 v[66:67], v228 offset:2304
  ds_read_b128 v[144:147], v223 offset:16384
  ds_read_b128 v[148:151], v223 offset:24576
  v_mfma_f32_32x32x16_bf16 v[36:51], v[68:71], v[156:159], v[36:51]
  s_add_u32 m0, s35, 1024
  s_add_u32 s3, s36, 557056
  buffer_load_dwordx4 v229, s[12:15], s3 offen lds
  v_fma_f32 v96, v112, v131, v96
  v_mul_f32 v97, v119, v132
  v_fma_f32 v97, v117, v133, v97
  v_fma_f32 v97, v115, v134, v97
  v_fma_f32 v97, v113, v135, v97
  s_waitcnt vmcnt(2)
  s_waitcnt lgkmcnt(2)
  v_mfma_f32_32x32x16_bf16 v[20:35], v[64:67], v[160:163], v[20:35]
  ds_read_b64_tr_b16 v[68:69], v228 offset:3072
  ds_read_b64_tr_b16 v[70:71], v228 offset:3328
  ds_read_b128 v[152:155], v216 offset:32768
  ds_read_b128 v[156:159], v216 offset:40960
  v_mfma_f32_32x32x16_bf16 v[36:51], v[64:67], v[164:167], v[36:51]
  s_add_u32 m0, s35, 2048
  s_add_u32 s3, s36, 589824
  buffer_load_dwordx4 v229, s[12:15], s3 offen lds
  v_mul_f32 v98, v120, v128
  v_fma_f32 v98, v118, v129, v98
  v_fma_f32 v98, v116, v130, v98
  v_fma_f32 v98, v114, v131, v98
  v_mul_f32 v99, v121, v132
  s_waitcnt vmcnt(2)
  s_waitcnt lgkmcnt(2)
  v_mfma_f32_32x32x16_bf16 v[20:35], v[68:71], v[144:147], v[20:35]
  ds_read_b64_tr_b16 v[64:65], v228 offset:0
  ds_read_b64_tr_b16 v[66:67], v228 offset:256
  ds_read_b128 v[160:163], v217 offset:32768
  ds_read_b128 v[164:167], v217 offset:40960
  v_mfma_f32_32x32x16_bf16 v[36:51], v[68:71], v[148:151], v[36:51]
  s_add_u32 m0, s35, 3072
  s_add_u32 s3, s36, 622592
  buffer_load_dwordx4 v229, s[12:15], s3 offen lds
  v_fma_f32 v99, v119, v133, v99
  v_fma_f32 v99, v117, v134, v99
  v_fma_f32 v99, v115, v135, v99
  v_mul_f32 v100, v122, v128
  v_fma_f32 v100, v120, v129, v100
  s_waitcnt vmcnt(2)
  s_waitcnt lgkmcnt(2)
  v_mfma_f32_32x32x16_bf16 v[20:35], v[64:67], v[152:155], v[20:35]
  ds_read_b64_tr_b16 v[68:69], v228 offset:1024
  ds_read_b64_tr_b16 v[70:71], v228 offset:1280
  ds_read_b128 v[144:147], v218 offset:32768
  ds_read_b128 v[148:151], v218 offset:40960
  v_mfma_f32_32x32x16_bf16 v[36:51], v[64:67], v[156:159], v[36:51]
  s_add_u32 m0, s35, 0
  s_add_u32 s3, s36, 655360
  buffer_load_dwordx4 v229, s[12:15], s3 offen lds
  v_fma_f32 v100, v118, v130, v100
  v_fma_f32 v100, v116, v131, v100
  v_mul_f32 v101, v123, v132
  v_fma_f32 v101, v121, v133, v101
  v_fma_f32 v101, v119, v134, v101
  s_waitcnt vmcnt(2)
  s_waitcnt lgkmcnt(2)
  v_mfma_f32_32x32x16_bf16 v[20:35], v[68:71], v[160:163], v[20:35]
  ds_read_b64_tr_b16 v[64:65], v228 offset:2048
  ds_read_b64_tr_b16 v[66:67], v228 offset:2304
  ds_read_b128 v[152:155], v219 offset:32768
  ds_read_b128 v[156:159], v219 offset:40960
  v_mfma_f32_32x32x16_bf16 v[36:51], v[68:71], v[164:167], v[36:51]
  s_add_u32 m0, s35, 1024
  s_add_u32 s3, s36, 688128
  buffer_load_dwordx4 v229, s[12:15], s3 offen lds
  v_fma_f32 v101, v117, v135, v101
  v_mul_f32 v102, v124, v128
  v_fma_f32 v102, v122, v129, v102
  v_fma_f32 v102, v120, v130, v102
  v_fma_f32 v102, v118, v131, v102
  s_waitcnt vmcnt(2)
  s_waitcnt lgkmcnt(2)
  v_mfma_f32_32x32x16_bf16 v[20:35], v[64:67], v[144:147], v[20:35]
  ds_read_b64_tr_b16 v[68:69], v228 offset:3072
  ds_read_b64_tr_b16 v[70:71], v228 offset:3328
  ds_read_b128 v[160:163], v220 offset:32768
  ds_read_b128 v[164:167], v220 offset:40960
  v_mfma_f32_32x32x16_bf16 v[36:51], v[64:67], v[148:151], v[36:51]
  s_add_u32 m0, s35, 2048
  s_add_u32 s3, s36, 720896
  buffer_load_dwordx4 v229, s[12:15], s3 offen lds
  v_mul_f32 v103, v125, v132
  v_fma_f32 v103, v123, v133, v103
  v_fma_f32 v103, v121, v134, v103
  v_fma_f32 v103, v119, v135, v103
  v_lshlrev_b32 v104, 16, v12
  s_waitcnt vmcnt(2)
  s_waitcnt lgkmcnt(2)
  v_mfma_f32_32x32x16_bf16 v[20:35], v[68:71], v[152:155], v[20:35]
  ds_read_b64_tr_b16 v[64:65], v228 offset:0
  ds_read_b64_tr_b16 v[66:67], v228 offset:256
  ds_read_b128 v[144:147], v221 offset:32768
  ds_read_b128 v[148:151], v221 offset:40960
  v_mfma_f32_32x32x16_bf16 v[36:51], v[68:71], v[156:159], v[36:51]
  s_add_u32 m0, s35, 3072
  s_add_u32 s3, s36, 753664
  buffer_load_dwordx4 v229, s[12:15], s3 offen lds
  v_and_b32 v105, 0xffff0000, v12
  v_lshlrev_b32 v106, 16, v13
  v_and_b32 v107, 0xffff0000, v13
  v_lshlrev_b32 v108, 16, v14
  v_and_b32 v109, 0xffff0000, v14
  s_waitcnt vmcnt(2)
  s_waitcnt lgkmcnt(2)
  v_mfma_f32_32x32x16_bf16 v[20:35], v[64:67], v[160:163], v[20:35]
  ds_read_b64_tr_b16 v[68:69], v228 offset:1024
  ds_read_b64_tr_b16 v[70:71], v228 offset:1280
  ds_read_b128 v[152:155], v222 offset:32768
  ds_read_b128 v[156:159], v222 offset:40960
  v_mfma_f32_32x32x16_bf16 v[36:51], v[64:67], v[164:167], v[36:51]
  s_add_u32 m0, s35, 0
  s_add_u32 s3, s36, 786432
  buffer_load_dwordx4 v229, s[12:15], s3 offen lds
  v_lshlrev_b32 v110, 16, v15
  v_and_b32 v111, 0xffff0000, v15
  v_lshlrev_b32 v112, 16, v16
  v_and_b32 v113, 0xffff0000, v16
  v_lshlrev_b32 v114, 16, v17
  s_waitcnt vmcnt(2)
  s_waitcnt lgkmcnt(2)
  v_mfma_f32_32x32x16_bf16 v[20:35], v[68:71], v[144:147], v[20:35]
  ds_read_b64_tr_b16 v[64:65], v228 offset:2048
  ds_read_b64_tr_b16 v[66:67], v228 offset:2304
  ds_read_b128 v[160:163], v223 offset:32768
  ds_read_b128 v[164:167], v223 offset:40960
  v_mfma_f32_32x32x16_bf16 v[36:51], v[68:71], v[148:151], v[36:51]
  s_add_u32 m0, s35, 1024
  s_add_u32 s3, s36, 819200
  buffer_load_dwordx4 v229, s[12:15], s3 offen lds
  v_and_b32 v115, 0xffff0000, v17
  v_lshlrev_b32 v116, 16, v18
  v_and_b32 v117, 0xffff0000, v18
  v_lshlrev_b32 v118, 16, v19
  v_and_b32 v119, 0xffff0000, v19
  s_waitcnt vmcnt(2)
  s_waitcnt lgkmcnt(2)
  v_mfma_f32_32x32x16_bf16 v[20:35], v[64:67], v[152:155], v[20:35]
  ds_read_b64_tr_b16 v[68:69], v228 offset:3072
  ds_read_b64_tr_b16 v[70:71], v228 offset:3328
  ds_read_b128 v[144:147], v216 offset:49152
  ds_read_b128 v[148:151], v216 offset:57344
  v_mfma_f32_32x32x16_bf16 v[36:51], v[64:67], v[156:159], v[36:51]
  s_add_u32 m0, s35, 2048
  s_add_u32 s3, s36, 851968
  buffer_load_dwordx4 v229, s[12:15], s3 offen lds
  v_mul_f32 v88, v88, v104
  v_mul_f32 v89, v89, v105
  v_mul_f32 v90, v90, v106
  v_mul_f32 v91, v91, v107
  v_mul_f32 v92, v92, v108
  s_waitcnt vmcnt(2)
  s_waitcnt lgkmcnt(2)
  v_mfma_f32_32x32x16_bf16 v[20:35], v[68:71], v[160:163], v[20:35]
  ds_read_b64_tr_b16 v[64:65], v228 offset:0
  ds_read_b64_tr_b16 v[66:67], v228 offset:256
  ds_read_b128 v[152:155], v217 offset:49152
  ds_read_b128 v[156:159], v217 offset:57344
  v_mfma_f32_32x32x16_bf16 v[36:51], v[68:71], v[164:167], v[36:51]
  s_add_u32 m0, s35, 3072
  s_add_u32 s3, s36, 884736
  buffer_load_dwordx4 v229, s[12:15], s3 offen lds
  v_mul_f32 v93, v93, v109
  v_mul_f32 v94, v94, v110
  v_mul_f32 v95, v95, v111
  v_mul_f32 v96, v96, v112
  v_mul_f32 v97, v97, v113
  s_waitcnt vmcnt(2)
  s_waitcnt lgkmcnt(2)
  v_mfma_f32_32x32x16_bf16 v[20:35], v[64:67], v[144:147], v[20:35]
  ds_read_b64_tr_b16 v[68:69], v228 offset:1024
  ds_read_b64_tr_b16 v[70:71], v228 offset:1280
  ds_read_b128 v[160:163], v218 offset:49152
  ds_read_b128 v[164:167], v218 offset:57344
  v_mfma_f32_32x32x16_bf16 v[36:51], v[64:67], v[148:151], v[36:51]
  s_add_u32 m0, s35, 0
  s_add_u32 s3, s36, 917504
  buffer_load_dwordx4 v229, s[12:15], s3 offen lds
  v_and_b32 v233, 31, v1
  v_lshlrev_b32 v233, 6, v233
  s_lshl_b32 s95, s4, 11
  s_add_u32 s95, s95, 17825792
  v_mul_f32 v98, v98, v114
  v_mul_f32 v99, v99, v115
  v_mul_f32 v100, v100, v116
  v_mul_f32 v101, v101, v117
  v_mul_f32 v102, v102, v118
  s_waitcnt vmcnt(2)
  s_waitcnt lgkmcnt(2)
  v_mfma_f32_32x32x16_bf16 v[20:35], v[68:71], v[152:155], v[20:35]
  ds_read_b64_tr_b16 v[64:65], v228 offset:2048
  ds_read_b64_tr_b16 v[66:67], v228 offset:2304
  ds_read_b128 v[144:147], v219 offset:49152
  ds_read_b128 v[148:151], v219 offset:57344
  v_mfma_f32_32x32x16_bf16 v[36:51], v[68:71], v[156:159], v[36:51]
  s_add_u32 m0, s35, 1024
  s_add_u32 s3, s36, 950272
  buffer_load_dwordx4 v229, s[12:15], s3 offen lds
  v_mul_f32 v103, v103, v119
  v_cvt_pk_bf16_f32 v136, v102, v100
  v_cvt_pk_bf16_f32 v137, v98, v96
  v_cvt_pk_bf16_f32 v138, v94, v92
  v_cvt_pk_bf16_f32 v139, v90, v88
  s_waitcnt vmcnt(2)
  s_waitcnt lgkmcnt(2)
  v_mfma_f32_32x32x16_bf16 v[20:35], v[64:67], v[160:163], v[20:35]
  ds_read_b64_tr_b16 v[68:69], v228 offset:3072
  ds_read_b64_tr_b16 v[70:71], v228 offset:3328
  ds_read_b128 v[152:155], v220 offset:49152
  ds_read_b128 v[156:159], v220 offset:57344
  v_mfma_f32_32x32x16_bf16 v[36:51], v[64:67], v[164:167], v[36:51]
  s_add_u32 m0, s35, 2048
  s_add_u32 s3, s36, 983040
  buffer_load_dwordx4 v229, s[12:15], s3 offen lds
  v_cvt_pk_bf16_f32 v140, v103, v101
  v_cvt_pk_bf16_f32 v141, v99, v97
  v_cvt_pk_bf16_f32 v142, v95, v93
  v_cvt_pk_bf16_f32 v143, v91, v89
  s_waitcnt vmcnt(2)
  s_waitcnt lgkmcnt(2)
  v_mfma_f32_32x32x16_bf16 v[20:35], v[68:71], v[144:147], v[20:35]
  ds_read_b64_tr_b16 v[64:65], v228 offset:0
  ds_read_b64_tr_b16 v[66:67], v228 offset:256
  ds_read_b128 v[160:163], v221 offset:49152
  ds_read_b128 v[164:167], v221 offset:57344
  v_mfma_f32_32x32x16_bf16 v[36:51], v[68:71], v[148:151], v[36:51]
  s_add_u32 m0, s35, 3072
  s_add_u32 s3, s36, 1015808
  buffer_load_dwordx4 v229, s[12:15], s3 offen lds
  s_waitcnt vmcnt(2)
  s_waitcnt lgkmcnt(2)
  v_mfma_f32_32x32x16_bf16 v[20:35], v[64:67], v[152:155], v[20:35]
  ds_read_b64_tr_b16 v[68:69], v228 offset:1024
  ds_read_b64_tr_b16 v[70:71], v228 offset:1280
  ds_read_b128 v[144:147], v222 offset:49152
  ds_read_b128 v[148:151], v222 offset:57344
  v_mfma_f32_32x32x16_bf16 v[36:51], v[64:67], v[156:159], v[36:51]
  buffer_load_dwordx4 v[52:55], v233, s[28:31], s95 offen sc1
  s_waitcnt vmcnt(2)
  s_waitcnt lgkmcnt(2)
  v_mfma_f32_32x32x16_bf16 v[20:35], v[68:71], v[160:163], v[20:35]
  ds_read_b64_tr_b16 v[64:65], v228 offset:2048
  ds_read_b64_tr_b16 v[66:67], v228 offset:2304
  ds_read_b128 v[152:155], v223 offset:49152
  ds_read_b128 v[156:159], v223 offset:57344
  v_mfma_f32_32x32x16_bf16 v[36:51], v[68:71], v[164:167], v[36:51]
  s_waitcnt vmcnt(1)
  s_waitcnt lgkmcnt(2)
  v_mfma_f32_32x32x16_bf16 v[20:35], v[64:67], v[144:147], v[20:35]
  ds_read_b64_tr_b16 v[68:69], v228 offset:3072
  ds_read_b64_tr_b16 v[70:71], v228 offset:3328
  v_mfma_f32_32x32x16_bf16 v[36:51], v[64:67], v[148:151], v[36:51]
  s_waitcnt lgkmcnt(0)
  v_mfma_f32_32x32x16_bf16 v[20:35], v[68:71], v[152:155], v[20:35]
  v_mfma_f32_32x32x16_bf16 v[36:51], v[68:71], v[156:159], v[36:51]
  s_waitcnt vmcnt(0)
  s_mov_b32 s3, 0
kvp_13:
  v_xor_b32 v52, s100, v52
  v_xor_b32 v53, s100, v53
  v_xor_b32 v54, s100, v54
  v_xor_b32 v55, s100, v55
  v_or_b32 v52, v52, v53
  v_or_b32 v54, v54, v55
  v_or_b32 v52, v52, v54
  v_cmp_ne_u32 vcc, 0, v52
  s_nop 4
  s_cmp_eq_u64 vcc, 0
  s_cbranch_scc1 kvc_12
  s_add_u32 s3, s3, 1
  s_cmp_ge_u32 s3, 200000
  s_cbranch_scc1 kvc_12
  s_sleep 1
  buffer_load_dwordx4 v[52:55], v233, s[28:31], s95 offen sc1
  s_waitcnt vmcnt(0)
  s_branch kvp_13
kvc_12:
  s_barrier
  v_lshlrev_b32 v2, 4, v1
  s_lshl_b32 s7, s4, 12
  s_add_u32 s7, s7, 65536
  v_add_u32 v228, s7, v2
  s_bitcmp1_b32 s4, 0
  s_cbranch_scc0 gr_14
  ds_write_b128 v228, v[20:23] offset:0
  ds_write_b128 v228, v[24:27] offset:1024
  ds_write_b128 v228, v[28:31] offset:2048
  ds_write_b128 v228, v[32:35] offset:3072
  s_nop 1
  v_mov_b32 v20, v36
  v_mov_b32 v21, v37
  v_mov_b32 v22, v38
  v_mov_b32 v23, v39
  v_mov_b32 v24, v40
  v_mov_b32 v25, v41
  v_mov_b32 v26, v42
  v_mov_b32 v27, v43
  v_mov_b32 v28, v44
  v_mov_b32 v29, v45
  v_mov_b32 v30, v46
  v_mov_b32 v31, v47
  v_mov_b32 v32, v48
  v_mov_b32 v33, v49
  v_mov_b32 v34, v50
  v_mov_b32 v35, v51
  s_branch gr_15
gr_14:
  ds_write_b128 v228, v[36:39] offset:0
  ds_write_b128 v228, v[40:43] offset:1024
  ds_write_b128 v228, v[44:47] offset:2048
  ds_write_b128 v228, v[48:51] offset:3072
gr_15:
  v_xor_b32 v228, 4096, v228
  v_mov_b32 v2, 163824
  v_mov_b32 v3, 0
  ds_write_b32 v2, v3
  s_sub_u32 s7, 7, s4
  v_and_b32 v2, 7, v1
  v_xor_b32 v2, s7, v2
  v_lshlrev_b32 v2, 4, v2
  v_lshl_add_u32 v2, v1, 8, v2
  v_add_u32 v2, 98304, v2
  ds_write_b128 v2, v[136:139]
  ds_write_b128 v2, v[140:143] offset:128
  v_lshlrev_b32 v234, 4, v1
  s_lshl_b32 s23, s4, 12
  s_add_u32 s22, s23, 16777216
  s_add_u32 m0, s23, 0
  s_nop 0
  buffer_load_dwordx4 v234, s[28:31], s22 offen offset:0 lds
  buffer_load_dwordx4 v234, s[28:31], s22 offen offset:1024 lds
  buffer_load_dwordx4 v234, s[28:31], s22 offen offset:2048 lds
  buffer_load_dwordx4 v234, s[28:31], s22 offen offset:3072 lds
  s_add_u32 s22, s22, 32768
  s_add_u32 m0, s23, 32768
  s_nop 0
  buffer_load_dwordx4 v234, s[28:31], s22 offen offset:0 lds
  buffer_load_dwordx4 v234, s[28:31], s22 offen offset:1024 lds
  buffer_load_dwordx4 v234, s[28:31], s22 offen offset:2048 lds
  buffer_load_dwordx4 v234, s[28:31], s22 offen offset:3072 lds
  s_add_u32 s22, s22, 32768
  s_lshr_b32 s16, s4, 1
  s_and_b32 s17, s4, 1
  s_lshl_b32 s18, s32, 2
  s_add_u32 s18, s18, s16
  s_lshl_b32 s7, s18, 12
  s_add_u32 s8, s72, s7
  s_addc_u32 s9, s73, 0
  s_mov_b32 s10, 4096
  s_mov_b32 s11, 0x20000
  s_add_u32 s7, s7, 4194304
  s_add_u32 s12, s92, s7
  s_addc_u32 s13, s93, 0
  s_mov_b32 s14, 4096
  s_mov_b32 s15, 0x20000
  s_mul_i32 s19, s16, 25920
  s_add_u32 s19, s19, 39616
  s_cmp_eq_u32 s16, 0
  s_cselect_b32 s19, 0, s19
  v_lshlrev_b32 v2, 4, v1
  v_add_u32 v144, -64, v2
  s_lshl_b32 s7, s17, 10
  v_add_u32 v145, s7, v2
  v_cmp_le_u32 vcc, 1, v1
  v_mov_b32 v2, 1
  v_mov_b32 v3, 0
  v_addc_co_u32 v2, vcc, 0, v2, vcc
  v_cmp_le_u32 vcc, 1, v1
  s_nop 1
  v_cndmask_b32 v3, 0, 1, vcc
  v_cmp_le_u32 vcc, 3, v1
  s_nop 1
  v_addc_co_u32 v2, vcc, 0, v2, vcc
  v_cmp_le_u32 vcc, 3, v1
  s_nop 1
  v_cndmask_b32 v3, v3, 3, vcc
  v_sub_u32 v3, v1, v3
  v_sub_u32 v4, v3, v2
  v_add_u32 v4, 4, v4
  v_lshlrev_b32 v4, 2, v4
  v_mul_u32_u24 v164, 4160, v2
  v_add_u32 v164, v164, v4
  v_add_u32 v164, 48, v164
  v_add_u32 v164, s19, v164
  v_lshlrev_b32 v165, 2, v3
  v_lshrrev_b32 v2, 1, v2
  v_cmp_eq_u32 vcc, s17, v2
  s_nop 1
  s_and_b64 s[26:27], vcc, 0x3f
  s_mov_b32 s96, s84
  s_mov_b32 s97, s85
  s_mov_b32 s98, 2097152
  s_mov_b32 s99, 0x20000
  v_and_b32 v2, 15, v1
  v_and_b32 v3, 7, v2
  v_lshlrev_b32 v3, 7, v3
  v_lshrrev_b32 v2, 3, v2
  v_lshl_add_u32 v166, v2, 11, v3
  s_lshr_b32 s7, s2, 3
  s_and_b32 s7, s7, 31
  s_lshl_b32 s7, s7, 16
  s_lshl_b32 s3, s4, 13
  s_add_u32 s95, s7, s3
  s_and_b32 s3, s2, 1
  s_lshl_b32 s3, s3, 10
  s_add_u32 s95, s95, s3
  v_and_b32 v2, 15, v1
  v_lshlrev_b32 v167, 7, v2
  s_waitcnt lgkmcnt(0)
  s_barrier
  ds_read_b128 v[168:171], v228 offset:0
  ds_read_b128 v[172:175], v228 offset:1024
  ds_read_b128 v[176:179], v228 offset:2048
  ds_read_b128 v[180:183], v228 offset:3072
  v_lshrrev_b32 v2, 3, v6
  v_bfe_u32 v3, v2, 1, 3
  v_and_b32 v4, 7, v6
  v_xor_b32 v5, v4, v3
  v_lshlrev_b32 v5, 4, v5
  v_lshl_add_u32 v5, v2, 7, v5
  v_add_u32 v5, 98304, v5
  ds_read_b128 v[184:187], v5
  ds_read_b128 v[188:191], v5 offset:8192
  s_lshl_b32 s7, s6, 7
  v_add_u32 v2, s7, v2
  v_lshlrev_b32 v2, 12, v2
  v_lshl_add_u32 v231, v4, 4, v2
  s_mov_b32 s7, 1048744942
  s_waitcnt lgkmcnt(2)
  v_add_f32 v20, v20, v168
  v_add_f32 v21, v21, v169
  v_add_f32 v22, v22, v170
  v_add_f32 v23, v23, v171
  v_add_f32 v24, v24, v172
  v_add_f32 v25, v25, v173
  v_add_f32 v26, v26, v174
  v_add_f32 v27, v27, v175
  v_add_f32 v28, v28, v176
  v_add_f32 v29, v29, v177
  v_add_f32 v30, v30, v178
  v_add_f32 v31, v31, v179
  v_add_f32 v32, v32, v180
  v_add_f32 v33, v33, v181
  v_add_f32 v34, v34, v182
  v_add_f32 v35, v35, v183
  v_mul_f32 v20, s7, v20
  v_mul_f32 v21, s7, v21
  v_mul_f32 v22, s7, v22
  v_mul_f32 v23, s7, v23
  v_mul_f32 v24, s7, v24
  v_mul_f32 v25, s7, v25
  v_mul_f32 v26, s7, v26
  v_mul_f32 v27, s7, v27
  v_mul_f32 v28, s7, v28
  v_mul_f32 v29, s7, v29
  v_mul_f32 v30, s7, v30
  v_mul_f32 v31, s7, v31
  v_mul_f32 v32, s7, v32
  v_mul_f32 v33, s7, v33
  v_mul_f32 v34, s7, v34
  v_mul_f32 v35, s7, v35
  v_cvt_pk_bf16_f32 v12, v20, v21
  v_cvt_pk_bf16_f32 v13, v22, v23
  v_cvt_pk_bf16_f32 v14, v24, v25
  v_cvt_pk_bf16_f32 v15, v26, v27
  v_cvt_pk_bf16_f32 v16, v28, v29
  v_cvt_pk_bf16_f32 v17, v30, v31
  v_cvt_pk_bf16_f32 v18, v32, v33
  v_cvt_pk_bf16_f32 v19, v34, v35
  s_waitcnt lgkmcnt(0)
  s_lshl_b32 s7, s5, 7
  s_sub_u32 s7, 4198272, s7
  buffer_store_dwordx4 v[184:187], v231, s[28:31], s7 offen sc1
  s_add_u32 s7, s7, 262144
  buffer_store_dwordx4 v[188:191], v231, s[28:31], s7 offen sc1
  v_and_b32 v2, 3, v1
  v_bfe_u32 v3, v1, 2, 1
  v_bfe_u32 v4, v1, 4, 1
  v_xor_b32 v3, v3, v4
  v_or_b32 v2, v2, v3
  v_cmp_eq_u32 vcc, 0, v2
  v_mov_b32 v2, 0x3f803f80
  v_lshlrev_b32 v20, 4, v1
  v_cndmask_b32 v140, 0, v2, vcc
  v_mov_b32 v141, v140
  v_mov_b32 v142, v140
  v_mov_b32 v143, v140
  v_mov_b32 v44, 0
  v_mov_b32 v45, 0
  v_mov_b32 v46, 0
  v_mov_b32 v47, 0
  v_mov_b32 v48, 0
  v_mov_b32 v49, 0
  v_mov_b32 v50, 0
  v_mov_b32 v51, 0
  v_mov_b32 v52, 0
  v_mov_b32 v53, 0
  v_mov_b32 v54, 0
  v_mov_b32 v55, 0
  v_mov_b32 v56, 0
  v_mov_b32 v57, 0
  v_mov_b32 v58, 0
  v_mov_b32 v59, 0
  s_mov_b32 s101, 0
attstart_16:
  s_lshl_b32 s23, s4, 12
  s_add_u32 s22, s23, 16777216
  s_cmp_eq_u32 s101, 0
  s_cbranch_scc1 pre_17
  s_add_u32 m0, s23, 0
  s_nop 0
  buffer_load_dwordx4 v20, s[28:31], s22 offen offset:0 lds
  buffer_load_dwordx4 v20, s[28:31], s22 offen offset:1024 lds
  buffer_load_dwordx4 v20, s[28:31], s22 offen offset:2048 lds
  buffer_load_dwordx4 v20, s[28:31], s22 offen offset:3072 lds
  s_add_u32 s22, s22, 32768
  s_add_u32 m0, s23, 32768
  s_nop 0
  buffer_load_dwordx4 v20, s[28:31], s22 offen offset:0 lds
  buffer_load_dwordx4 v20, s[28:31], s22 offen offset:1024 lds
  buffer_load_dwordx4 v20, s[28:31], s22 offen offset:2048 lds
  buffer_load_dwordx4 v20, s[28:31], s22 offen offset:3072 lds
  s_add_u32 s22, s22, 32768
  s_waitcnt vmcnt(0)
  s_sub_u32 s22, s22, 65536
pre_17:
  s_add_u32 s22, s22, 65536
  v_mov_b32 v24, 0
  v_mov_b32 v25, 0
  v_mov_b32 v26, 0
  v_mov_b32 v27, 0
  v_mov_b32 v28, 0
  v_mov_b32 v29, 0
  v_mov_b32 v30, 0
  v_mov_b32 v31, 0
  v_mov_b32 v32, 0
  v_mov_b32 v33, 0
  v_mov_b32 v34, 0
  v_mov_b32 v35, 0
  v_mov_b32 v36, 0
  v_mov_b32 v37, 0
  v_mov_b32 v38, 0
  v_mov_b32 v39, 0
  v_mov_b32 v40, 0
  v_mov_b32 v41, 0
  v_mov_b32 v42, 0
  v_mov_b32 v43, 0
  v_mov_b32 v100, 0
  v_mov_b32 v101, 0
  v_mov_b32 v102, 0
  v_mov_b32 v103, 0
  v_mov_b32 v104, 0
  v_mov_b32 v105, 0
  v_mov_b32 v106, 0
  v_mov_b32 v107, 0
  v_mov_b32 v132, 0
  v_mov_b32 v133, 0
  v_mov_b32 v134, 0
  v_mov_b32 v135, 0
  v_mov_b32 v136, 0
  v_mov_b32 v137, 0
  v_mov_b32 v138, 0
  v_mov_b32 v139, 0
  s_mov_b32 s21, 65536
  s_mov_b32 s20, 0
  v_mov_b32 v21, v20
  v_add_u32 v22, 32768, v20
  s_waitcnt vmcnt(6)
  s_barrier
  ds_read_b128 v[108:111], v21 offset:0
  ds_read_b128 v[112:115], v21 offset:1024
  ds_read_b128 v[116:119], v21 offset:4096
  ds_read_b128 v[120:123], v21 offset:5120
  s_waitcnt lgkmcnt(2)
  v_mfma_f32_32x32x16_bf16 v[60:75], v[108:111], v[12:15], v[44:59]
  v_mfma_f32_32x32x16_bf16 v[60:75], v[112:115], v[16:19], v[60:75]
  s_nop 13
.p2align 6
attn_18:
  s_waitcnt lgkmcnt(0)
  v_mfma_f32_32x32x16_bf16 v[76:91], v[116:119], v[12:15], v[44:59]
  ds_read_b128 v[108:111], v21 offset:8192
  v_exp_f32 v60, v60
  v_exp_f32 v61, v61
  v_exp_f32 v62, v62
  v_mfma_f32_32x32x16_bf16 v[24:39], v[132:135], v[100:103], v[24:39]
  ds_read_b128 v[112:115], v21 offset:9216
  v_exp_f32 v63, v63
  v_exp_f32 v64, v64
  v_exp_f32 v65, v65
  v_mfma_f32_32x32x16_bf16 v[76:91], v[120:123], v[16:19], v[76:91]
  ds_read_b128 v[124:127], v21 offset:2048
  v_exp_f32 v66, v66
  v_exp_f32 v67, v67
  v_cvt_pk_bf16_f32 v92, v60, v61
  v_cvt_pk_bf16_f32 v93, v62, v63
  v_mfma_f32_16x16x32_bf16 v[40:43], v[140:143], v[100:103], v[40:43]
  ds_read_b128 v[128:131], v21 offset:3072
  v_exp_f32 v68, v68
  v_exp_f32 v69, v69
  v_cvt_pk_bf16_f32 v94, v64, v65
  v_mfma_f32_32x32x16_bf16 v[24:39], v[136:139], v[104:107], v[24:39]
  v_exp_f32 v70, v70
  v_exp_f32 v71, v71
  v_exp_f32 v72, v72
  v_cvt_pk_bf16_f32 v95, v66, v67
  v_mfma_f32_16x16x32_bf16 v[40:43], v[140:143], v[104:107], v[40:43]
  v_exp_f32 v73, v73
  v_exp_f32 v74, v74
  v_exp_f32 v75, v75
  v_cvt_pk_bf16_f32 v96, v68, v69
  v_cvt_pk_bf16_f32 v97, v70, v71
  v_cvt_pk_bf16_f32 v98, v72, v73
  v_cvt_pk_bf16_f32 v99, v74, v75
  s_waitcnt lgkmcnt(0)
  v_mfma_f32_32x32x16_bf16 v[60:75], v[108:111], v[12:15], v[44:59]
  ds_read_b128 v[116:119], v21 offset:12288
  v_exp_f32 v76, v76
  v_exp_f32 v77, v77
  v_exp_f32 v78, v78
  v_mfma_f32_32x32x16_bf16 v[24:39], v[124:127], v[92:95], v[24:39]
  ds_read_b128 v[120:123], v21 offset:13312
  v_exp_f32 v79, v79
  v_exp_f32 v80, v80
  v_exp_f32 v81, v81
  v_mfma_f32_32x32x16_bf16 v[60:75], v[112:115], v[16:19], v[60:75]
  ds_read_b128 v[132:135], v21 offset:6144
  v_exp_f32 v82, v82
  v_exp_f32 v83, v83
  v_cvt_pk_bf16_f32 v100, v76, v77
  v_cvt_pk_bf16_f32 v101, v78, v79
  v_mfma_f32_16x16x32_bf16 v[40:43], v[140:143], v[92:95], v[40:43]
  ds_read_b128 v[136:139], v21 offset:7168
  v_exp_f32 v84, v84
  v_exp_f32 v85, v85
  v_cvt_pk_bf16_f32 v102, v80, v81
  v_mfma_f32_32x32x16_bf16 v[24:39], v[128:131], v[96:99], v[24:39]
  s_and_b32 s38, s20, 1
  s_lshl_b32 s38, s38, 12
  s_add_u32 s38, s38, s95
  s_mov_b64 exec, 0xffff
  buffer_load_dword v8, v166, s[96:99], s38 offen
  s_lshl_b32 s38, s20, 11
  s_and_b32 s38, s38, 2048
  buffer_load_dword v8, v167, s[8:11], s38 offen
  s_mov_b64 exec, -1
  v_exp_f32 v86, v86
  v_exp_f32 v87, v87
  v_exp_f32 v88, v88
  v_cvt_pk_bf16_f32 v103, v82, v83
  v_mfma_f32_16x16x32_bf16 v[40:43], v[140:143], v[96:99], v[40:43]
  v_exp_f32 v89, v89
  v_exp_f32 v90, v90
  v_exp_f32 v91, v91
  v_cvt_pk_bf16_f32 v104, v84, v85
  v_cvt_pk_bf16_f32 v105, v86, v87
  v_cvt_pk_bf16_f32 v106, v88, v89
  v_cvt_pk_bf16_f32 v107, v90, v91
  s_waitcnt lgkmcnt(0)
  v_mfma_f32_32x32x16_bf16 v[76:91], v[116:119], v[12:15], v[44:59]
  ds_read_b128 v[108:111], v21 offset:16384
  v_exp_f32 v60, v60
  v_exp_f32 v61, v61
  v_exp_f32 v62, v62
  v_mfma_f32_32x32x16_bf16 v[24:39], v[132:135], v[100:103], v[24:39]
  ds_read_b128 v[112:115], v21 offset:17408
  v_exp_f32 v63, v63
  v_exp_f32 v64, v64
  v_exp_f32 v65, v65
  v_mfma_f32_32x32x16_bf16 v[76:91], v[120:123], v[16:19], v[76:91]
  ds_read_b128 v[124:127], v21 offset:10240
  v_exp_f32 v66, v66
  v_exp_f32 v67, v67
  v_cvt_pk_bf16_f32 v92, v60, v61
  v_cvt_pk_bf16_f32 v93, v62, v63
  v_mfma_f32_16x16x32_bf16 v[40:43], v[140:143], v[100:103], v[40:43]
  ds_read_b128 v[128:131], v21 offset:11264
  v_exp_f32 v68, v68
  v_exp_f32 v69, v69
  v_cvt_pk_bf16_f32 v94, v64, v65
  v_mfma_f32_32x32x16_bf16 v[24:39], v[136:139], v[104:107], v[24:39]
  v_exp_f32 v70, v70
  v_exp_f32 v71, v71
  v_exp_f32 v72, v72
  v_cvt_pk_bf16_f32 v95, v66, v67
  v_mfma_f32_16x16x32_bf16 v[40:43], v[140:143], v[104:107], v[40:43]
  v_exp_f32 v73, v73
  v_exp_f32 v74, v74
  v_exp_f32 v75, v75
  v_cvt_pk_bf16_f32 v96, v68, v69
  v_cvt_pk_bf16_f32 v97, v70, v71
  v_cvt_pk_bf16_f32 v98, v72, v73
  v_cvt_pk_bf16_f32 v99, v74, v75
  s_waitcnt lgkmcnt(0)
  v_mfma_f32_32x32x16_bf16 v[60:75], v[108:111], v[12:15], v[44:59]
  ds_read_b128 v[116:119], v21 offset:20480
  v_exp_f32 v76, v76
  v_exp_f32 v77, v77
  v_exp_f32 v78, v78
  v_mfma_f32_32x32x16_bf16 v[24:39], v[124:127], v[92:95], v[24:39]
  ds_read_b128 v[120:123], v21 offset:21504
  v_exp_f32 v79, v79
  v_exp_f32 v80, v80
  v_exp_f32 v81, v81
  v_mfma_f32_32x32x16_bf16 v[60:75], v[112:115], v[16:19], v[60:75]
  ds_read_b128 v[132:135], v21 offset:14336
  v_exp_f32 v82, v82
  v_exp_f32 v83, v83
  v_cvt_pk_bf16_f32 v100, v76, v77
  v_cvt_pk_bf16_f32 v101, v78, v79
  v_mfma_f32_16x16x32_bf16 v[40:43], v[140:143], v[92:95], v[40:43]
  ds_read_b128 v[136:139], v21 offset:15360
  v_exp_f32 v84, v84
  v_exp_f32 v85, v85
  v_cvt_pk_bf16_f32 v102, v80, v81
  v_mfma_f32_32x32x16_bf16 v[24:39], v[128:131], v[96:99], v[24:39]
  v_exp_f32 v86, v86
  v_exp_f32 v87, v87
  v_exp_f32 v88, v88
  v_cvt_pk_bf16_f32 v103, v82, v83
  v_mfma_f32_16x16x32_bf16 v[40:43], v[140:143], v[96:99], v[40:43]
  v_exp_f32 v89, v89
  v_exp_f32 v90, v90
  v_exp_f32 v91, v91
  v_cvt_pk_bf16_f32 v104, v84, v85
  v_cvt_pk_bf16_f32 v105, v86, v87
  v_cvt_pk_bf16_f32 v106, v88, v89
  v_cvt_pk_bf16_f32 v107, v90, v91
  s_waitcnt lgkmcnt(0)
  v_mfma_f32_32x32x16_bf16 v[76:91], v[116:119], v[12:15], v[44:59]
  ds_read_b128 v[108:111], v21 offset:24576
  v_exp_f32 v60, v60
  v_exp_f32 v61, v61
  v_exp_f32 v62, v62
  v_mfma_f32_32x32x16_bf16 v[24:39], v[132:135], v[100:103], v[24:39]
  ds_read_b128 v[112:115], v21 offset:25600
  v_exp_f32 v63, v63
  v_exp_f32 v64, v64
  v_exp_f32 v65, v65
  v_mfma_f32_32x32x16_bf16 v[76:91], v[120:123], v[16:19], v[76:91]
  ds_read_b128 v[124:127], v21 offset:18432
  v_exp_f32 v66, v66
  v_exp_f32 v67, v67
  v_cvt_pk_bf16_f32 v92, v60, v61
  v_cvt_pk_bf16_f32 v93, v62, v63
  v_mfma_f32_16x16x32_bf16 v[40:43], v[140:143], v[100:103], v[40:43]
  ds_read_b128 v[128:131], v21 offset:19456
  v_exp_f32 v68, v68
  v_exp_f32 v69, v69
  v_cvt_pk_bf16_f32 v94, v64, v65
  v_mfma_f32_32x32x16_bf16 v[24:39], v[136:139], v[104:107], v[24:39]
  v_exp_f32 v70, v70
  v_exp_f32 v71, v71
  v_exp_f32 v72, v72
  v_cvt_pk_bf16_f32 v95, v66, v67
  v_mfma_f32_16x16x32_bf16 v[40:43], v[140:143], v[104:107], v[40:43]
  v_exp_f32 v73, v73
  v_exp_f32 v74, v74
  v_exp_f32 v75, v75
  v_cvt_pk_bf16_f32 v96, v68, v69
  v_cvt_pk_bf16_f32 v97, v70, v71
  v_cvt_pk_bf16_f32 v98, v72, v73
  v_cvt_pk_bf16_f32 v99, v74, v75
  s_waitcnt lgkmcnt(0)
  v_mfma_f32_32x32x16_bf16 v[60:75], v[108:111], v[12:15], v[44:59]
  ds_read_b128 v[116:119], v21 offset:28672
  v_exp_f32 v76, v76
  v_exp_f32 v77, v77
  v_exp_f32 v78, v78
  v_mfma_f32_32x32x16_bf16 v[24:39], v[124:127], v[92:95], v[24:39]
  ds_read_b128 v[120:123], v21 offset:29696
  v_exp_f32 v79, v79
  v_exp_f32 v80, v80
  v_exp_f32 v81, v81
  v_mfma_f32_32x32x16_bf16 v[60:75], v[112:115], v[16:19], v[60:75]
  ds_read_b128 v[132:135], v21 offset:22528
  v_exp_f32 v82, v82
  v_exp_f32 v83, v83
  v_cvt_pk_bf16_f32 v100, v76, v77
  v_cvt_pk_bf16_f32 v101, v78, v79
  v_mfma_f32_16x16x32_bf16 v[40:43], v[140:143], v[92:95], v[40:43]
  ds_read_b128 v[136:139], v21 offset:23552
  v_exp_f32 v84, v84
  v_exp_f32 v85, v85
  v_cvt_pk_bf16_f32 v102, v80, v81
  v_mfma_f32_32x32x16_bf16 v[24:39], v[128:131], v[96:99], v[24:39]
  v_exp_f32 v86, v86
  v_exp_f32 v87, v87
  v_exp_f32 v88, v88
  v_cvt_pk_bf16_f32 v103, v82, v83
  v_mfma_f32_16x16x32_bf16 v[40:43], v[140:143], v[96:99], v[40:43]
  v_exp_f32 v89, v89
  v_exp_f32 v90, v90
  v_exp_f32 v91, v91
  v_cvt_pk_bf16_f32 v104, v84, v85
  v_cvt_pk_bf16_f32 v105, v86, v87
  v_cvt_pk_bf16_f32 v106, v88, v89
  v_cvt_pk_bf16_f32 v107, v90, v91
  s_cmp_lg_u32 s20, 5
  s_cbranch_scc1 h5_19
  s_cmp_lg_u32 s4, 0
  s_cbranch_scc1 wt_20
  v_and_b32 v2, 31, v1
  v_lshlrev_b32 v2, 6, v2
  s_lshl_b32 s7, s6, 11
  s_add_u32 s7, s7, 17842176
  s_mov_b32 s3, 0
poll_21:
  buffer_load_dword v8, v2, s[28:31], s7 offen sc1
  s_waitcnt vmcnt(0)
  v_xor_b32 v8, s100, v8
  v_cmp_ne_u32 vcc, 0, v8
  s_nop 4
  s_cmp_eq_u64 vcc, 0
  s_cbranch_scc1 wt_20
  s_add_u32 s3, s3, 1
  s_cmp_lt_u32 s3, 200000
  s_sleep 1
  s_cbranch_scc1 poll_21
wt_20:
h5_19:
  s_waitcnt vmcnt(2)
  s_barrier
  s_add_u32 m0, s23, s21
  s_cmp_lg_u32 s20, 1
  s_cbranch_scc1 h0_22
  s_cmp_lg_u32 s4, 0
  s_cbranch_scc1 pub_23
  s_lshl_b32 s7, s32, 6
  s_add_u32 s7, s7, 17842176
  v_mov_b32 v2, 0
  v_mov_b32 v3, s100
  s_mov_b64 exec, 1
  buffer_store_dword v3, v2, s[28:31], s7 offen sc1
  s_mov_b64 exec, -1
pub_23:
h0_22:
  s_waitcnt lgkmcnt(0)
  v_mfma_f32_32x32x16_bf16 v[76:91], v[116:119], v[12:15], v[44:59]
  ds_read_b128 v[108:111], v22 offset:0
  v_exp_f32 v60, v60
  v_exp_f32 v61, v61
  v_exp_f32 v62, v62
  v_mfma_f32_32x32x16_bf16 v[24:39], v[132:135], v[100:103], v[24:39]
  ds_read_b128 v[112:115], v22 offset:1024
  v_exp_f32 v63, v63
  v_exp_f32 v64, v64
  v_exp_f32 v65, v65
  v_mfma_f32_32x32x16_bf16 v[76:91], v[120:123], v[16:19], v[76:91]
  ds_read_b128 v[124:127], v21 offset:26624
  v_exp_f32 v66, v66
  v_exp_f32 v67, v67
  v_cvt_pk_bf16_f32 v92, v60, v61
  v_cvt_pk_bf16_f32 v93, v62, v63
  v_mfma_f32_16x16x32_bf16 v[40:43], v[140:143], v[100:103], v[40:43]
  ds_read_b128 v[128:131], v21 offset:27648
  v_exp_f32 v68, v68
  v_exp_f32 v69, v69
  v_cvt_pk_bf16_f32 v94, v64, v65
  v_mfma_f32_32x32x16_bf16 v[24:39], v[136:139], v[104:107], v[24:39]
  buffer_load_dwordx4 v20, s[28:31], s22 offen offset:0 lds
  v_exp_f32 v70, v70
  v_exp_f32 v71, v71
  v_exp_f32 v72, v72
  v_cvt_pk_bf16_f32 v95, v66, v67
  v_mfma_f32_16x16x32_bf16 v[40:43], v[140:143], v[104:107], v[40:43]
  buffer_load_dwordx4 v20, s[28:31], s22 offen offset:1024 lds
  v_exp_f32 v73, v73
  v_exp_f32 v74, v74
  v_exp_f32 v75, v75
  v_cvt_pk_bf16_f32 v96, v68, v69
  v_cvt_pk_bf16_f32 v97, v70, v71
  v_cvt_pk_bf16_f32 v98, v72, v73
  v_cvt_pk_bf16_f32 v99, v74, v75
  s_waitcnt lgkmcnt(0)
  v_mfma_f32_32x32x16_bf16 v[60:75], v[108:111], v[12:15], v[44:59]
  ds_read_b128 v[116:119], v22 offset:4096
  v_exp_f32 v76, v76
  v_exp_f32 v77, v77
  v_exp_f32 v78, v78
  v_mfma_f32_32x32x16_bf16 v[24:39], v[124:127], v[92:95], v[24:39]
  ds_read_b128 v[120:123], v22 offset:5120
  v_exp_f32 v79, v79
  v_exp_f32 v80, v80
  v_exp_f32 v81, v81
  v_mfma_f32_32x32x16_bf16 v[60:75], v[112:115], v[16:19], v[60:75]
  ds_read_b128 v[132:135], v21 offset:30720
  v_exp_f32 v82, v82
  v_exp_f32 v83, v83
  v_cvt_pk_bf16_f32 v100, v76, v77
  v_cvt_pk_bf16_f32 v101, v78, v79
  v_mfma_f32_16x16x32_bf16 v[40:43], v[140:143], v[92:95], v[40:43]
  ds_read_b128 v[136:139], v21 offset:31744
  v_exp_f32 v84, v84
  v_exp_f32 v85, v85
  v_cvt_pk_bf16_f32 v102, v80, v81
  v_mfma_f32_32x32x16_bf16 v[24:39], v[128:131], v[96:99], v[24:39]
  buffer_load_dwordx4 v20, s[28:31], s22 offen offset:2048 lds
  v_exp_f32 v86, v86
  v_exp_f32 v87, v87
  v_exp_f32 v88, v88
  v_cvt_pk_bf16_f32 v103, v82, v83
  v_mfma_f32_16x16x32_bf16 v[40:43], v[140:143], v[96:99], v[40:43]
  buffer_load_dwordx4 v20, s[28:31], s22 offen offset:3072 lds
  v_exp_f32 v89, v89
  v_exp_f32 v90, v90
  v_exp_f32 v91, v91
  v_cvt_pk_bf16_f32 v104, v84, v85
  v_cvt_pk_bf16_f32 v105, v86, v87
  v_cvt_pk_bf16_f32 v106, v88, v89
  v_cvt_pk_bf16_f32 v107, v90, v91
  s_add_u32 s22, s22, 32768
  s_add_u32 s21, s21, 32768
  s_cmp_eq_u32 s21, 98304
  s_cselect_b32 s21, 0, s21
  v_mov_b32 v21, v22
  v_add_u32 v22, 32768, v22
  v_cmp_le_u32 vcc, 98304, v22
  v_subrev_u32 v2, 98304, v22
  s_add_u32 s20, s20, 1
  v_cndmask_b32 v22, v22, v2, vcc
  s_cmp_lt_u32 s20, 6
  s_cbranch_scc1 attn_18
  s_waitcnt lgkmcnt(0)
  v_mfma_f32_32x32x16_bf16 v[76:91], v[116:119], v[12:15], v[44:59]
  ds_read_b128 v[108:111], v21 offset:8192
  v_exp_f32 v60, v60
  v_exp_f32 v61, v61
  v_exp_f32 v62, v62
  v_mfma_f32_32x32x16_bf16 v[24:39], v[132:135], v[100:103], v[24:39]
  ds_read_b128 v[112:115], v21 offset:9216
  v_exp_f32 v63, v63
  v_exp_f32 v64, v64
  v_exp_f32 v65, v65
  v_mfma_f32_32x32x16_bf16 v[76:91], v[120:123], v[16:19], v[76:91]
  ds_read_b128 v[124:127], v21 offset:2048
  v_exp_f32 v66, v66
  v_exp_f32 v67, v67
  v_cvt_pk_bf16_f32 v92, v60, v61
  v_cvt_pk_bf16_f32 v93, v62, v63
  v_mfma_f32_16x16x32_bf16 v[40:43], v[140:143], v[100:103], v[40:43]
  ds_read_b128 v[128:131], v21 offset:3072
  v_exp_f32 v68, v68
  v_exp_f32 v69, v69
  v_cvt_pk_bf16_f32 v94, v64, v65
  v_mfma_f32_32x32x16_bf16 v[24:39], v[136:139], v[104:107], v[24:39]
  v_exp_f32 v70, v70
  v_exp_f32 v71, v71
  v_exp_f32 v72, v72
  v_cvt_pk_bf16_f32 v95, v66, v67
  v_mfma_f32_16x16x32_bf16 v[40:43], v[140:143], v[104:107], v[40:43]
  v_exp_f32 v73, v73
  v_exp_f32 v74, v74
  v_exp_f32 v75, v75
  v_cvt_pk_bf16_f32 v96, v68, v69
  v_cvt_pk_bf16_f32 v97, v70, v71
  v_cvt_pk_bf16_f32 v98, v72, v73
  v_cvt_pk_bf16_f32 v99, v74, v75
  s_waitcnt lgkmcnt(0)
  v_mfma_f32_32x32x16_bf16 v[60:75], v[108:111], v[12:15], v[44:59]
  ds_read_b128 v[116:119], v21 offset:12288
  v_exp_f32 v76, v76
  v_exp_f32 v77, v77
  v_exp_f32 v78, v78
  v_mfma_f32_32x32x16_bf16 v[24:39], v[124:127], v[92:95], v[24:39]
  ds_read_b128 v[120:123], v21 offset:13312
  v_exp_f32 v79, v79
  v_exp_f32 v80, v80
  v_exp_f32 v81, v81
  v_mfma_f32_32x32x16_bf16 v[60:75], v[112:115], v[16:19], v[60:75]
  ds_read_b128 v[132:135], v21 offset:6144
  v_exp_f32 v82, v82
  v_exp_f32 v83, v83
  v_cvt_pk_bf16_f32 v100, v76, v77
  v_cvt_pk_bf16_f32 v101, v78, v79
  v_mfma_f32_16x16x32_bf16 v[40:43], v[140:143], v[92:95], v[40:43]
  ds_read_b128 v[136:139], v21 offset:7168
  v_exp_f32 v84, v84
  v_exp_f32 v85, v85
  v_cvt_pk_bf16_f32 v102, v80, v81
  v_mfma_f32_32x32x16_bf16 v[24:39], v[128:131], v[96:99], v[24:39]
  v_exp_f32 v86, v86
  v_exp_f32 v87, v87
  v_exp_f32 v88, v88
  v_cvt_pk_bf16_f32 v103, v82, v83
  v_mfma_f32_16x16x32_bf16 v[40:43], v[140:143], v[96:99], v[40:43]
  v_exp_f32 v89, v89
  v_exp_f32 v90, v90
  v_exp_f32 v91, v91
  v_cvt_pk_bf16_f32 v104, v84, v85
  v_cvt_pk_bf16_f32 v105, v86, v87
  v_cvt_pk_bf16_f32 v106, v88, v89
  v_cvt_pk_bf16_f32 v107, v90, v91
  s_waitcnt lgkmcnt(0)
  v_mfma_f32_32x32x16_bf16 v[76:91], v[116:119], v[12:15], v[44:59]
  ds_read_b128 v[108:111], v21 offset:16384
  v_exp_f32 v60, v60
  v_exp_f32 v61, v61
  v_exp_f32 v62, v62
  v_mfma_f32_32x32x16_bf16 v[24:39], v[132:135], v[100:103], v[24:39]
  ds_read_b128 v[112:115], v21 offset:17408
  v_exp_f32 v63, v63
  v_exp_f32 v64, v64
  v_exp_f32 v65, v65
  v_mfma_f32_32x32x16_bf16 v[76:91], v[120:123], v[16:19], v[76:91]
  ds_read_b128 v[124:127], v21 offset:10240
  v_exp_f32 v66, v66
  v_exp_f32 v67, v67
  v_cvt_pk_bf16_f32 v92, v60, v61
  v_cvt_pk_bf16_f32 v93, v62, v63
  v_mfma_f32_16x16x32_bf16 v[40:43], v[140:143], v[100:103], v[40:43]
  ds_read_b128 v[128:131], v21 offset:11264
  v_exp_f32 v68, v68
  v_exp_f32 v69, v69
  v_cvt_pk_bf16_f32 v94, v64, v65
  v_mfma_f32_32x32x16_bf16 v[24:39], v[136:139], v[104:107], v[24:39]
  v_exp_f32 v70, v70
  v_exp_f32 v71, v71
  v_exp_f32 v72, v72
  v_cvt_pk_bf16_f32 v95, v66, v67
  v_mfma_f32_16x16x32_bf16 v[40:43], v[140:143], v[104:107], v[40:43]
  v_exp_f32 v73, v73
  v_exp_f32 v74, v74
  v_exp_f32 v75, v75
  v_cvt_pk_bf16_f32 v96, v68, v69
  v_cvt_pk_bf16_f32 v97, v70, v71
  v_cvt_pk_bf16_f32 v98, v72, v73
  v_cvt_pk_bf16_f32 v99, v74, v75
  s_waitcnt lgkmcnt(0)
  v_mfma_f32_32x32x16_bf16 v[60:75], v[108:111], v[12:15], v[44:59]
  ds_read_b128 v[116:119], v21 offset:20480
  v_exp_f32 v76, v76
  v_exp_f32 v77, v77
  v_exp_f32 v78, v78
  v_mfma_f32_32x32x16_bf16 v[24:39], v[124:127], v[92:95], v[24:39]
  ds_read_b128 v[120:123], v21 offset:21504
  v_exp_f32 v79, v79
  v_exp_f32 v80, v80
  v_exp_f32 v81, v81
  v_mfma_f32_32x32x16_bf16 v[60:75], v[112:115], v[16:19], v[60:75]
  ds_read_b128 v[132:135], v21 offset:14336
  v_exp_f32 v82, v82
  v_exp_f32 v83, v83
  v_cvt_pk_bf16_f32 v100, v76, v77
  v_cvt_pk_bf16_f32 v101, v78, v79
  v_mfma_f32_16x16x32_bf16 v[40:43], v[140:143], v[92:95], v[40:43]
  ds_read_b128 v[136:139], v21 offset:15360
  v_exp_f32 v84, v84
  v_exp_f32 v85, v85
  v_cvt_pk_bf16_f32 v102, v80, v81
  v_mfma_f32_32x32x16_bf16 v[24:39], v[128:131], v[96:99], v[24:39]
  v_exp_f32 v86, v86
  v_exp_f32 v87, v87
  v_exp_f32 v88, v88
  v_cvt_pk_bf16_f32 v103, v82, v83
  v_mfma_f32_16x16x32_bf16 v[40:43], v[140:143], v[96:99], v[40:43]
  v_exp_f32 v89, v89
  v_exp_f32 v90, v90
  v_exp_f32 v91, v91
  v_cvt_pk_bf16_f32 v104, v84, v85
  v_cvt_pk_bf16_f32 v105, v86, v87
  v_cvt_pk_bf16_f32 v106, v88, v89
  v_cvt_pk_bf16_f32 v107, v90, v91
  s_waitcnt lgkmcnt(0)
  v_mfma_f32_32x32x16_bf16 v[76:91], v[116:119], v[12:15], v[44:59]
  ds_read_b128 v[108:111], v21 offset:24576
  v_exp_f32 v60, v60
  v_exp_f32 v61, v61
  v_exp_f32 v62, v62
  v_mfma_f32_32x32x16_bf16 v[24:39], v[132:135], v[100:103], v[24:39]
  ds_read_b128 v[112:115], v21 offset:25600
  v_exp_f32 v63, v63
  v_exp_f32 v64, v64
  v_exp_f32 v65, v65
  v_mfma_f32_32x32x16_bf16 v[76:91], v[120:123], v[16:19], v[76:91]
  ds_read_b128 v[124:127], v21 offset:18432
  v_exp_f32 v66, v66
  v_exp_f32 v67, v67
  v_cvt_pk_bf16_f32 v92, v60, v61
  v_cvt_pk_bf16_f32 v93, v62, v63
  v_mfma_f32_16x16x32_bf16 v[40:43], v[140:143], v[100:103], v[40:43]
  ds_read_b128 v[128:131], v21 offset:19456
  v_exp_f32 v68, v68
  v_exp_f32 v69, v69
  v_cvt_pk_bf16_f32 v94, v64, v65
  v_mfma_f32_32x32x16_bf16 v[24:39], v[136:139], v[104:107], v[24:39]
  v_exp_f32 v70, v70
  v_exp_f32 v71, v71
  v_exp_f32 v72, v72
  v_cvt_pk_bf16_f32 v95, v66, v67
  v_mfma_f32_16x16x32_bf16 v[40:43], v[140:143], v[104:107], v[40:43]
  v_exp_f32 v73, v73
  v_exp_f32 v74, v74
  v_exp_f32 v75, v75
  v_cvt_pk_bf16_f32 v96, v68, v69
  v_cvt_pk_bf16_f32 v97, v70, v71
  v_cvt_pk_bf16_f32 v98, v72, v73
  v_cvt_pk_bf16_f32 v99, v74, v75
  s_waitcnt lgkmcnt(0)
  v_mfma_f32_32x32x16_bf16 v[60:75], v[108:111], v[12:15], v[44:59]
  ds_read_b128 v[116:119], v21 offset:28672
  v_exp_f32 v76, v76
  v_exp_f32 v77, v77
  v_exp_f32 v78, v78
  v_mfma_f32_32x32x16_bf16 v[24:39], v[124:127], v[92:95], v[24:39]
  ds_read_b128 v[120:123], v21 offset:29696
  v_exp_f32 v79, v79
  v_exp_f32 v80, v80
  v_exp_f32 v81, v81
  v_mfma_f32_32x32x16_bf16 v[60:75], v[112:115], v[16:19], v[60:75]
  ds_read_b128 v[132:135], v21 offset:22528
  v_exp_f32 v82, v82
  v_exp_f32 v83, v83
  v_cvt_pk_bf16_f32 v100, v76, v77
  v_cvt_pk_bf16_f32 v101, v78, v79
  v_mfma_f32_16x16x32_bf16 v[40:43], v[140:143], v[92:95], v[40:43]
  ds_read_b128 v[136:139], v21 offset:23552
  v_exp_f32 v84, v84
  v_exp_f32 v85, v85
  v_cvt_pk_bf16_f32 v102, v80, v81
  v_mfma_f32_32x32x16_bf16 v[24:39], v[128:131], v[96:99], v[24:39]
  v_exp_f32 v86, v86
  v_exp_f32 v87, v87
  v_exp_f32 v88, v88
  v_cvt_pk_bf16_f32 v103, v82, v83
  v_mfma_f32_16x16x32_bf16 v[40:43], v[140:143], v[96:99], v[40:43]
  v_exp_f32 v89, v89
  v_exp_f32 v90, v90
  v_exp_f32 v91, v91
  v_cvt_pk_bf16_f32 v104, v84, v85
  v_cvt_pk_bf16_f32 v105, v86, v87
  v_cvt_pk_bf16_f32 v106, v88, v89
  v_cvt_pk_bf16_f32 v107, v90, v91
  s_waitcnt vmcnt(0)
  s_barrier
  s_waitcnt lgkmcnt(0)
  v_mfma_f32_32x32x16_bf16 v[76:91], v[116:119], v[12:15], v[44:59]
  ds_read_b128 v[108:111], v22 offset:0
  v_exp_f32 v60, v60
  v_exp_f32 v61, v61
  v_exp_f32 v62, v62
  v_mfma_f32_32x32x16_bf16 v[24:39], v[132:135], v[100:103], v[24:39]
  ds_read_b128 v[112:115], v22 offset:1024
  v_exp_f32 v63, v63
  v_exp_f32 v64, v64
  v_exp_f32 v65, v65
  v_mfma_f32_32x32x16_bf16 v[76:91], v[120:123], v[16:19], v[76:91]
  ds_read_b128 v[124:127], v21 offset:26624
  v_exp_f32 v66, v66
  v_exp_f32 v67, v67
  v_cvt_pk_bf16_f32 v92, v60, v61
  v_cvt_pk_bf16_f32 v93, v62, v63
  v_mfma_f32_16x16x32_bf16 v[40:43], v[140:143], v[100:103], v[40:43]
  ds_read_b128 v[128:131], v21 offset:27648
  v_exp_f32 v68, v68
  v_exp_f32 v69, v69
  v_cvt_pk_bf16_f32 v94, v64, v65
  v_mfma_f32_32x32x16_bf16 v[24:39], v[136:139], v[104:107], v[24:39]
  v_exp_f32 v70, v70
  v_exp_f32 v71, v71
  v_exp_f32 v72, v72
  v_cvt_pk_bf16_f32 v95, v66, v67
  v_mfma_f32_16x16x32_bf16 v[40:43], v[140:143], v[104:107], v[40:43]
  v_exp_f32 v73, v73
  v_exp_f32 v74, v74
  v_exp_f32 v75, v75
  v_cvt_pk_bf16_f32 v96, v68, v69
  v_cvt_pk_bf16_f32 v97, v70, v71
  v_cvt_pk_bf16_f32 v98, v72, v73
  v_cvt_pk_bf16_f32 v99, v74, v75
  s_waitcnt lgkmcnt(0)
  v_mfma_f32_32x32x16_bf16 v[60:75], v[108:111], v[12:15], v[44:59]
  ds_read_b128 v[116:119], v22 offset:4096
  v_exp_f32 v76, v76
  v_exp_f32 v77, v77
  v_exp_f32 v78, v78
  v_mfma_f32_32x32x16_bf16 v[24:39], v[124:127], v[92:95], v[24:39]
  ds_read_b128 v[120:123], v22 offset:5120
  v_exp_f32 v79, v79
  v_exp_f32 v80, v80
  v_exp_f32 v81, v81
  v_mfma_f32_32x32x16_bf16 v[60:75], v[112:115], v[16:19], v[60:75]
  ds_read_b128 v[132:135], v21 offset:30720
  v_exp_f32 v82, v82
  v_exp_f32 v83, v83
  v_cvt_pk_bf16_f32 v100, v76, v77
  v_cvt_pk_bf16_f32 v101, v78, v79
  v_mfma_f32_16x16x32_bf16 v[40:43], v[140:143], v[92:95], v[40:43]
  ds_read_b128 v[136:139], v21 offset:31744
  v_exp_f32 v84, v84
  v_exp_f32 v85, v85
  v_cvt_pk_bf16_f32 v102, v80, v81
  v_mfma_f32_32x32x16_bf16 v[24:39], v[128:131], v[96:99], v[24:39]
  v_exp_f32 v86, v86
  v_exp_f32 v87, v87
  v_exp_f32 v88, v88
  v_cvt_pk_bf16_f32 v103, v82, v83
  v_mfma_f32_16x16x32_bf16 v[40:43], v[140:143], v[96:99], v[40:43]
  v_exp_f32 v89, v89
  v_exp_f32 v90, v90
  v_exp_f32 v91, v91
  v_cvt_pk_bf16_f32 v104, v84, v85
  v_cvt_pk_bf16_f32 v105, v86, v87
  v_cvt_pk_bf16_f32 v106, v88, v89
  v_cvt_pk_bf16_f32 v107, v90, v91
  v_mov_b32 v21, v22
  v_add_u32 v22, 32768, v22
  v_cmp_le_u32 vcc, 98304, v22
  v_subrev_u32 v2, 98304, v22
  s_add_u32 s20, s20, 1
  v_cndmask_b32 v22, v22, v2, vcc
  s_waitcnt lgkmcnt(0)
  s_barrier
  s_waitcnt lgkmcnt(0)
  v_mfma_f32_32x32x16_bf16 v[76:91], v[116:119], v[12:15], v[44:59]
  ds_read_b128 v[108:111], v21 offset:8192
  v_exp_f32 v60, v60
  v_exp_f32 v61, v61
  v_exp_f32 v62, v62
  v_mfma_f32_32x32x16_bf16 v[24:39], v[132:135], v[100:103], v[24:39]
  ds_read_b128 v[112:115], v21 offset:9216
  v_exp_f32 v63, v63
  v_exp_f32 v64, v64
  v_exp_f32 v65, v65
  v_mfma_f32_32x32x16_bf16 v[76:91], v[120:123], v[16:19], v[76:91]
  ds_read_b128 v[124:127], v21 offset:2048
  v_exp_f32 v66, v66
  v_exp_f32 v67, v67
  v_cvt_pk_bf16_f32 v92, v60, v61
  v_cvt_pk_bf16_f32 v93, v62, v63
  v_mfma_f32_16x16x32_bf16 v[40:43], v[140:143], v[100:103], v[40:43]
  ds_read_b128 v[128:131], v21 offset:3072
  v_exp_f32 v68, v68
  v_exp_f32 v69, v69
  v_cvt_pk_bf16_f32 v94, v64, v65
  v_mfma_f32_32x32x16_bf16 v[24:39], v[136:139], v[104:107], v[24:39]
  s_movk_i32 s38, 0
  buffer_load_dwordx4 v[148:151], v145, s[12:15], s38 offen
  buffer_load_dword v160, v145, s[12:15], s38 offen offset:16
  v_exp_f32 v70, v70
  v_exp_f32 v71, v71
  v_exp_f32 v72, v72
  v_cvt_pk_bf16_f32 v95, v66, v67
  v_mfma_f32_16x16x32_bf16 v[40:43], v[140:143], v[104:107], v[40:43]
  s_movk_i32 s38, 2048
  buffer_load_dwordx4 v[152:155], v145, s[12:15], s38 offen
  buffer_load_dword v161, v145, s[12:15], s38 offen offset:16
  v_exp_f32 v73, v73
  v_exp_f32 v74, v74
  v_exp_f32 v75, v75
  v_cvt_pk_bf16_f32 v96, v68, v69
  v_cvt_pk_bf16_f32 v97, v70, v71
  v_cvt_pk_bf16_f32 v98, v72, v73
  v_cvt_pk_bf16_f32 v99, v74, v75
  s_waitcnt lgkmcnt(0)
  v_mfma_f32_32x32x16_bf16 v[60:75], v[108:111], v[12:15], v[44:59]
  ds_read_b128 v[116:119], v21 offset:12288
  v_exp_f32 v76, v76
  v_exp_f32 v77, v77
  v_exp_f32 v78, v78
  v_mfma_f32_32x32x16_bf16 v[24:39], v[124:127], v[92:95], v[24:39]
  ds_read_b128 v[120:123], v21 offset:13312
  v_exp_f32 v79, v79
  v_exp_f32 v80, v80
  v_exp_f32 v81, v81
  v_mfma_f32_32x32x16_bf16 v[60:75], v[112:115], v[16:19], v[60:75]
  ds_read_b128 v[132:135], v21 offset:6144
  v_exp_f32 v82, v82
  v_exp_f32 v83, v83
  v_cvt_pk_bf16_f32 v100, v76, v77
  v_cvt_pk_bf16_f32 v101, v78, v79
  v_mfma_f32_16x16x32_bf16 v[40:43], v[140:143], v[92:95], v[40:43]
  ds_read_b128 v[136:139], v21 offset:7168
  v_exp_f32 v84, v84
  v_exp_f32 v85, v85
  v_cvt_pk_bf16_f32 v102, v80, v81
  v_mfma_f32_32x32x16_bf16 v[24:39], v[128:131], v[96:99], v[24:39]
  s_movk_i32 s38, 4096
  buffer_load_dwordx4 v[156:159], v145, s[12:15], s38 offen
  buffer_load_dword v162, v145, s[12:15], s38 offen offset:16
  v_exp_f32 v86, v86
  v_exp_f32 v87, v87
  v_exp_f32 v88, v88
  v_cvt_pk_bf16_f32 v103, v82, v83
  v_mfma_f32_16x16x32_bf16 v[40:43], v[140:143], v[96:99], v[40:43]
  buffer_load_dword v163, v165, s[8:11], 0 offen
  v_exp_f32 v89, v89
  v_exp_f32 v90, v90
  v_exp_f32 v91, v91
  v_cvt_pk_bf16_f32 v104, v84, v85
  v_cvt_pk_bf16_f32 v105, v86, v87
  v_cvt_pk_bf16_f32 v106, v88, v89
  v_cvt_pk_bf16_f32 v107, v90, v91
  s_waitcnt lgkmcnt(0)
  v_mfma_f32_32x32x16_bf16 v[76:91], v[116:119], v[12:15], v[44:59]
  ds_read_b128 v[108:111], v21 offset:16384
  v_exp_f32 v60, v60
  v_exp_f32 v61, v61
  v_exp_f32 v62, v62
  v_mfma_f32_32x32x16_bf16 v[24:39], v[132:135], v[100:103], v[24:39]
  ds_read_b128 v[112:115], v21 offset:17408
  v_exp_f32 v63, v63
  v_exp_f32 v64, v64
  v_exp_f32 v65, v65
  v_mfma_f32_32x32x16_bf16 v[76:91], v[120:123], v[16:19], v[76:91]
  ds_read_b128 v[124:127], v21 offset:10240
  v_exp_f32 v66, v66
  v_exp_f32 v67, v67
  v_cvt_pk_bf16_f32 v92, v60, v61
  v_cvt_pk_bf16_f32 v93, v62, v63
  v_mfma_f32_16x16x32_bf16 v[40:43], v[140:143], v[100:103], v[40:43]
  ds_read_b128 v[128:131], v21 offset:11264
  v_exp_f32 v68, v68
  v_exp_f32 v69, v69
  v_cvt_pk_bf16_f32 v94, v64, v65
  v_mfma_f32_32x32x16_bf16 v[24:39], v[136:139], v[104:107], v[24:39]
  s_mul_i32 s39, s17, 8320
  s_add_u32 s39, s39, s19
  s_lshl_b32 s61, s17, 3
  s_add_u32 m0, s39, 0
  s_add_u32 s38, s61, 0
  buffer_load_dwordx4 v144, s[8:11], s38 offen lds
  v_exp_f32 v70, v70
  v_exp_f32 v71, v71
  v_exp_f32 v72, v72
  v_cvt_pk_bf16_f32 v95, v66, v67
  v_mfma_f32_16x16x32_bf16 v[40:43], v[140:143], v[104:107], v[40:43]
  s_add_u32 m0, s39, 1024
  s_add_u32 s38, s61, 960
  buffer_load_dwordx4 v20, s[8:11], s38 offen lds
  v_exp_f32 v73, v73
  v_exp_f32 v74, v74
  v_exp_f32 v75, v75
  v_cvt_pk_bf16_f32 v96, v68, v69
  v_cvt_pk_bf16_f32 v97, v70, v71
  v_cvt_pk_bf16_f32 v98, v72, v73
  v_cvt_pk_bf16_f32 v99, v74, v75
  s_waitcnt lgkmcnt(0)
  v_mfma_f32_32x32x16_bf16 v[60:75], v[108:111], v[12:15], v[44:59]
  ds_read_b128 v[116:119], v21 offset:20480
  v_exp_f32 v76, v76
  v_exp_f32 v77, v77
  v_exp_f32 v78, v78
  v_mfma_f32_32x32x16_bf16 v[24:39], v[124:127], v[92:95], v[24:39]
  ds_read_b128 v[120:123], v21 offset:21504
  v_exp_f32 v79, v79
  v_exp_f32 v80, v80
  v_exp_f32 v81, v81
  v_mfma_f32_32x32x16_bf16 v[60:75], v[112:115], v[16:19], v[60:75]
  ds_read_b128 v[132:135], v21 offset:14336
  v_exp_f32 v82, v82
  v_exp_f32 v83, v83
  v_cvt_pk_bf16_f32 v100, v76, v77
  v_cvt_pk_bf16_f32 v101, v78, v79
  v_mfma_f32_16x16x32_bf16 v[40:43], v[140:143], v[92:95], v[40:43]
  ds_read_b128 v[136:139], v21 offset:15360
  v_exp_f32 v84, v84
  v_exp_f32 v85, v85
  v_cvt_pk_bf16_f32 v102, v80, v81
  v_mfma_f32_32x32x16_bf16 v[24:39], v[128:131], v[96:99], v[24:39]
  s_add_u32 m0, s39, 2048
  s_add_u32 s38, s61, 1984
  buffer_load_dwordx4 v20, s[8:11], s38 offen lds
  v_exp_f32 v86, v86
  v_exp_f32 v87, v87
  v_exp_f32 v88, v88
  v_cvt_pk_bf16_f32 v103, v82, v83
  v_mfma_f32_16x16x32_bf16 v[40:43], v[140:143], v[96:99], v[40:43]
  s_add_u32 m0, s39, 3072
  s_add_u32 s38, s61, 3008
  buffer_load_dwordx4 v20, s[8:11], s38 offen lds
  v_exp_f32 v89, v89
  v_exp_f32 v90, v90
  v_exp_f32 v91, v91
  v_cvt_pk_bf16_f32 v104, v84, v85
  v_cvt_pk_bf16_f32 v105, v86, v87
  v_cvt_pk_bf16_f32 v106, v88, v89
  v_cvt_pk_bf16_f32 v107, v90, v91
  s_waitcnt lgkmcnt(0)
  v_mfma_f32_32x32x16_bf16 v[76:91], v[116:119], v[12:15], v[44:59]
  ds_read_b128 v[108:111], v21 offset:24576
  v_exp_f32 v60, v60
  v_exp_f32 v61, v61
  v_exp_f32 v62, v62
  v_mfma_f32_32x32x16_bf16 v[24:39], v[132:135], v[100:103], v[24:39]
  ds_read_b128 v[112:115], v21 offset:25600
  v_exp_f32 v63, v63
  v_exp_f32 v64, v64
  v_exp_f32 v65, v65
  v_mfma_f32_32x32x16_bf16 v[76:91], v[120:123], v[16:19], v[76:91]
  ds_read_b128 v[124:127], v21 offset:18432
  v_exp_f32 v66, v66
  v_exp_f32 v67, v67
  v_cvt_pk_bf16_f32 v92, v60, v61
  v_cvt_pk_bf16_f32 v93, v62, v63
  v_mfma_f32_16x16x32_bf16 v[40:43], v[140:143], v[100:103], v[40:43]
  ds_read_b128 v[128:131], v21 offset:19456
  v_exp_f32 v68, v68
  v_exp_f32 v69, v69
  v_cvt_pk_bf16_f32 v94, v64, v65
  v_mfma_f32_32x32x16_bf16 v[24:39], v[136:139], v[104:107], v[24:39]
  s_add_u32 m0, s39, 4096
  s_add_u32 s38, s61, 4032
  s_mov_b64 exec, 0xf
  buffer_load_dwordx4 v20, s[8:11], s38 offen lds
  s_mov_b64 exec, -1
  v_exp_f32 v70, v70
  v_exp_f32 v71, v71
  v_exp_f32 v72, v72
  v_cvt_pk_bf16_f32 v95, v66, v67
  v_mfma_f32_16x16x32_bf16 v[40:43], v[140:143], v[104:107], v[40:43]
  s_add_u32 m0, s39, 4160
  s_add_u32 s38, s61, 4
  buffer_load_dwordx4 v144, s[8:11], s38 offen lds
  v_exp_f32 v73, v73
  v_exp_f32 v74, v74
  v_exp_f32 v75, v75
  v_cvt_pk_bf16_f32 v96, v68, v69
  v_cvt_pk_bf16_f32 v97, v70, v71
  v_cvt_pk_bf16_f32 v98, v72, v73
  v_cvt_pk_bf16_f32 v99, v74, v75
  s_waitcnt lgkmcnt(0)
  v_mfma_f32_32x32x16_bf16 v[60:75], v[108:111], v[12:15], v[44:59]
  ds_read_b128 v[116:119], v21 offset:28672
  v_exp_f32 v76, v76
  v_exp_f32 v77, v77
  v_exp_f32 v78, v78
  v_mfma_f32_32x32x16_bf16 v[24:39], v[124:127], v[92:95], v[24:39]
  ds_read_b128 v[120:123], v21 offset:29696
  v_exp_f32 v79, v79
  v_exp_f32 v80, v80
  v_exp_f32 v81, v81
  v_mfma_f32_32x32x16_bf16 v[60:75], v[112:115], v[16:19], v[60:75]
  ds_read_b128 v[132:135], v21 offset:22528
  v_exp_f32 v82, v82
  v_exp_f32 v83, v83
  v_cvt_pk_bf16_f32 v100, v76, v77
  v_cvt_pk_bf16_f32 v101, v78, v79
  v_mfma_f32_16x16x32_bf16 v[40:43], v[140:143], v[92:95], v[40:43]
  ds_read_b128 v[136:139], v21 offset:23552
  v_exp_f32 v84, v84
  v_exp_f32 v85, v85
  v_cvt_pk_bf16_f32 v102, v80, v81
  v_mfma_f32_32x32x16_bf16 v[24:39], v[128:131], v[96:99], v[24:39]
  s_add_u32 m0, s39, 5184
  s_add_u32 s38, s61, 964
  buffer_load_dwordx4 v20, s[8:11], s38 offen lds
  v_exp_f32 v86, v86
  v_exp_f32 v87, v87
  v_exp_f32 v88, v88
  v_cvt_pk_bf16_f32 v103, v82, v83
  v_mfma_f32_16x16x32_bf16 v[40:43], v[140:143], v[96:99], v[40:43]
  s_add_u32 m0, s39, 6208
  s_add_u32 s38, s61, 1988
  buffer_load_dwordx4 v20, s[8:11], s38 offen lds
  v_exp_f32 v89, v89
  v_exp_f32 v90, v90
  v_exp_f32 v91, v91
  v_cvt_pk_bf16_f32 v104, v84, v85
  v_cvt_pk_bf16_f32 v105, v86, v87
  v_cvt_pk_bf16_f32 v106, v88, v89
  v_cvt_pk_bf16_f32 v107, v90, v91
  s_waitcnt lgkmcnt(0)
  v_mfma_f32_32x32x16_bf16 v[76:91], v[116:119], v[12:15], v[44:59]
  ds_read_b128 v[124:127], v21 offset:26624
  v_exp_f32 v60, v60
  v_exp_f32 v61, v61
  v_exp_f32 v62, v62
  v_mfma_f32_32x32x16_bf16 v[24:39], v[132:135], v[100:103], v[24:39]
  ds_read_b128 v[128:131], v21 offset:27648
  v_exp_f32 v63, v63
  v_exp_f32 v64, v64
  v_exp_f32 v65, v65
  v_mfma_f32_32x32x16_bf16 v[76:91], v[120:123], v[16:19], v[76:91]
  v_exp_f32 v66, v66
  v_exp_f32 v67, v67
  v_cvt_pk_bf16_f32 v92, v60, v61
  v_cvt_pk_bf16_f32 v93, v62, v63
  v_mfma_f32_16x16x32_bf16 v[40:43], v[140:143], v[100:103], v[40:43]
  v_exp_f32 v68, v68
  v_exp_f32 v69, v69
  v_cvt_pk_bf16_f32 v94, v64, v65
  v_mfma_f32_32x32x16_bf16 v[24:39], v[136:139], v[104:107], v[24:39]
  s_add_u32 m0, s39, 7232
  s_add_u32 s38, s61, 3012
  buffer_load_dwordx4 v20, s[8:11], s38 offen lds
  v_exp_f32 v70, v70
  v_exp_f32 v71, v71
  v_exp_f32 v72, v72
  v_cvt_pk_bf16_f32 v95, v66, v67
  v_mfma_f32_16x16x32_bf16 v[40:43], v[140:143], v[104:107], v[40:43]
  s_add_u32 m0, s39, 8256
  s_add_u32 s38, s61, 4036
  s_mov_b64 exec, 0xf
  buffer_load_dwordx4 v20, s[8:11], s38 offen lds
  s_mov_b64 exec, -1
  v_exp_f32 v73, v73
  v_exp_f32 v74, v74
  v_exp_f32 v75, v75
  v_cvt_pk_bf16_f32 v96, v68, v69
  v_cvt_pk_bf16_f32 v97, v70, v71
  v_cvt_pk_bf16_f32 v98, v72, v73
  v_cvt_pk_bf16_f32 v99, v74, v75
  s_waitcnt lgkmcnt(0)
  ds_read_b128 v[132:135], v21 offset:30720
  v_exp_f32 v76, v76
  v_exp_f32 v77, v77
  v_exp_f32 v78, v78
  v_mfma_f32_32x32x16_bf16 v[24:39], v[124:127], v[92:95], v[24:39]
  ds_read_b128 v[136:139], v21 offset:31744
  v_exp_f32 v79, v79
  v_exp_f32 v80, v80
  v_exp_f32 v81, v81
  v_exp_f32 v82, v82
  v_exp_f32 v83, v83
  v_cvt_pk_bf16_f32 v100, v76, v77
  v_cvt_pk_bf16_f32 v101, v78, v79
  v_mfma_f32_16x16x32_bf16 v[40:43], v[140:143], v[92:95], v[40:43]
  v_exp_f32 v84, v84
  v_exp_f32 v85, v85
  v_cvt_pk_bf16_f32 v102, v80, v81
  v_mfma_f32_32x32x16_bf16 v[24:39], v[128:131], v[96:99], v[24:39]
  v_exp_f32 v86, v86
  v_exp_f32 v87, v87
  v_exp_f32 v88, v88
  v_cvt_pk_bf16_f32 v103, v82, v83
  v_mfma_f32_16x16x32_bf16 v[40:43], v[140:143], v[96:99], v[40:43]
  v_exp_f32 v89, v89
  v_exp_f32 v90, v90
  v_exp_f32 v91, v91
  v_cvt_pk_bf16_f32 v104, v84, v85
  v_cvt_pk_bf16_f32 v105, v86, v87
  v_cvt_pk_bf16_f32 v106, v88, v89
  v_cvt_pk_bf16_f32 v107, v90, v91
  s_waitcnt lgkmcnt(0)
  v_mfma_f32_32x32x16_bf16 v[24:39], v[132:135], v[100:103], v[24:39]
  v_mfma_f32_16x16x32_bf16 v[40:43], v[140:143], v[100:103], v[40:43]
  v_mfma_f32_32x32x16_bf16 v[24:39], v[136:139], v[104:107], v[24:39]
  v_mfma_f32_16x16x32_bf16 v[40:43], v[140:143], v[104:107], v[40:43]
  s_nop 15
  s_mov_b32 s7, 528482304
  s_mov_b32 s3, 1602224128
  v_cmp_nge_f32 vcc, v40, s7
  v_cmp_nle_f32 s[62:63], v40, s3
  v_rcp_f32 v4, v40
  s_nop 0
  s_or_b64 vcc, vcc, s[62:63]
  s_cmp_eq_u64 vcc, 0
  s_cbranch_scc1 lok_24
  v_mov_b32 v2, 163824
  v_mov_b32 v3, 1
  ds_write_b32 v2, v3
lok_24:
  v_mul_f32 v24, v4, v24
  v_mul_f32 v25, v4, v25
  v_mul_f32 v26, v4, v26
  v_mul_f32 v27, v4, v27
  v_mul_f32 v28, v4, v28
  v_mul_f32 v29, v4, v29
  v_mul_f32 v30, v4, v30
  v_mul_f32 v31, v4, v31
  v_mul_f32 v32, v4, v32
  v_mul_f32 v33, v4, v33
  v_mul_f32 v34, v4, v34
  v_mul_f32 v35, v4, v35
  v_mul_f32 v36, v4, v36
  v_mul_f32 v37, v4, v37
  v_mul_f32 v38, v4, v38
  v_mul_f32 v39, v4, v39
  v_cvt_pk_bf16_f32 v92, v24, v25
  v_cvt_pk_bf16_f32 v93, v26, v27
  v_cvt_pk_bf16_f32 v94, v28, v29
  v_cvt_pk_bf16_f32 v95, v30, v31
  v_cvt_pk_bf16_f32 v96, v32, v33
  v_cvt_pk_bf16_f32 v97, v34, v35
  v_cvt_pk_bf16_f32 v98, v36, v37
  v_cvt_pk_bf16_f32 v99, v38, v39
  s_lshl_b32 s35, s4, 12
  s_add_u32 s35, s35, 32768
  s_lshl_b32 s37, s4, 11
  s_add_u32 s37, s37, 143360
  v_and_b32 v2, 31, v1
  v_bfe_u32 v3, v1, 1, 2
  v_lshrrev_b32 v5, 5, v1
  v_lshlrev_b32 v5, 1, v5
  v_xor_b32 v3, v3, v5
  v_lshlrev_b32 v3, 4, v3
  v_lshl_add_u32 v2, v2, 6, v3
  v_add_u32 v2, s37, v2
  v_xor_b32 v3, 16, v2
  ds_write_b128 v2, v[92:95]
  ds_write_b128 v3, v[96:99]
  v_lshrrev_b32 v2, 2, v1
  v_bfe_u32 v3, v1, 3, 2
  v_and_b32 v5, 3, v1
  v_xor_b32 v3, v3, v5
  v_lshlrev_b32 v3, 4, v3
  v_lshl_add_u32 v3, v2, 6, v3
  v_add_u32 v70, s37, v3
  v_lshlrev_b32 v3, 4, v5
  v_lshl_add_u32 v3, v2, 11, v3
  s_lshl_b32 s7, s6, 8
  s_lshr_b32 s3, s4, 1
  s_lshl_b32 s3, s3, 6
  s_add_u32 s7, s7, s3
  v_add_u32 v123, s7, v3
  s_and_b32 s36, s4, 1
  s_lshl_b32 s36, s36, 20
  s_and_b32 s7, s4, 1
  s_lshl_b32 s7, s7, 5
  s_lshl_b32 s3, s5, 6
  s_add_u32 s7, s7, s3
  v_add_u32 v2, s7, v2
  v_lshlrev_b32 v2, 11, v2
  v_lshl_add_u32 v68, v5, 4, v2
  s_lshr_b32 s7, s4, 1
  s_lshl_b32 s3, s6, 2
  s_add_u32 s7, s7, s3
  s_lshl_b32 s7, s7, 6
  s_add_u32 s7, s7, 8388608
  s_waitcnt lgkmcnt(0)
  ds_read_b128 v[60:63], v70
  ds_read_b128 v[64:67], v70 offset:1024
  s_waitcnt lgkmcnt(1)
  buffer_store_dwordx4 v[60:63], v68, s[28:31], s7 offen sc1
  s_add_u32 s7, s7, 32768
  s_waitcnt lgkmcnt(0)
  buffer_store_dwordx4 v[64:67], v68, s[28:31], s7 offen sc1
  s_waitcnt vmcnt(2)
  v_add_u32 v3, s19, v145
  ds_write_b128 v3, v[148:151] offset:21280
  v_alignbit_b32 v168, v149, v148, 16
  v_alignbit_b32 v169, v150, v149, 16
  v_alignbit_b32 v170, v151, v150, 16
  v_alignbit_b32 v171, v160, v151, 16
  ds_write_b128 v3, v[168:171] offset:16640
  s_nop 1
  ds_write_b128 v3, v[152:155] offset:23328
  v_alignbit_b32 v168, v153, v152, 16
  v_alignbit_b32 v169, v154, v153, 16
  v_alignbit_b32 v170, v155, v154, 16
  v_alignbit_b32 v171, v161, v155, 16
  ds_write_b128 v3, v[168:171] offset:18688
  s_nop 1
  v_cmp_gt_u32 vcc, 448, v145
  s_and_saveexec_b64 s[62:63], vcc
  s_cbranch_execz cvb_27
  ds_write_b128 v3, v[156:159] offset:25376
  v_alignbit_b32 v168, v157, v156, 16
  v_alignbit_b32 v169, v158, v157, 16
  v_alignbit_b32 v170, v159, v158, 16
  v_alignbit_b32 v171, v162, v159, 16
  ds_write_b128 v3, v[168:171] offset:20736
  s_nop 1
cvb_27:
  s_mov_b64 exec, s[62:63]
  s_cmp_eq_u64 s[26:27], 0
  s_cbranch_scc1 cvp_28
  s_mov_b64 exec, s[26:27]
  ds_write_b32 v164, v163
  s_mov_b64 exec, -1
cvp_28:
  v_and_b32 v2, 3, v1
  v_lshlrev_b32 v2, 3, v2
  v_bfe_u32 v3, v1, 4, 1
  v_lshl_add_u32 v2, v3, 5, v2
  v_bfe_u32 v3, v1, 2, 2
  v_lshrrev_b32 v4, 5, v1
  v_lshl_add_u32 v3, v4, 3, v3
  v_lshl_add_u32 v2, v3, 6, v2
  v_add_u32 v122, s35, v2
  s_and_b32 s7, s4, 3
  s_lshl_b32 s7, s7, 4
  v_lshrrev_b32 v2, 4, v1
  v_and_b32 v3, 15, v1
  v_add_u32 v4, 0, v2
  v_xor_b32 v5, v3, v4
  v_lshlrev_b32 v5, 4, v5
  v_add_u32 v4, s7, v4
  v_lshl_add_u32 v124, v4, 11, v5
  v_add_u32 v4, 4, v2
  v_xor_b32 v5, v3, v4
  v_lshlrev_b32 v5, 4, v5
  v_add_u32 v4, s7, v4
  v_lshl_add_u32 v125, v4, 11, v5
  v_add_u32 v4, 8, v2
  v_xor_b32 v5, v3, v4
  v_lshlrev_b32 v5, 4, v5
  v_add_u32 v4, s7, v4
  v_lshl_add_u32 v126, v4, 11, v5
  v_add_u32 v4, 12, v2
  v_xor_b32 v5, v3, v4
  v_lshlrev_b32 v5, 4, v5
  v_add_u32 v4, s7, v4
  v_lshl_add_u32 v127, v4, 11, v5
  s_lshr_b32 s60, s4, 2
  s_lshl_b32 s61, s5, 17
  s_lshl_b32 s7, s60, 10
  s_add_u32 s61, s61, s7
  s_lshl_b32 s60, s60, 16
  s_and_b32 s7, s4, 3
  s_lshl_b32 s7, s7, 12
  s_add_u32 s60, s60, s7
  s_add_u32 s8, s92, 8388608
  s_addc_u32 s9, s93, 0
  s_mov_b32 s10, 4194304
  s_mov_b32 s11, 0x20000
  v_and_b32 v10, 7, v1
  v_lshlrev_b32 v10, 11, v10
  s_lshl_b32 s95, s5, 6
  s_add_u32 s95, s95, 17858560
  v_and_b32 v2, 3, v1
  v_add_u32 v2, 1, v2
  v_lshrrev_b32 v3, 2, v2
  v_and_b32 v2, 3, v2
  v_mul_u32_u24 v2, 4160, v2
  v_bfe_u32 v4, v1, 2, 2
  v_add_u32 v3, v3, v4
  v_lshrrev_b32 v4, 4, v1
  v_add_u32 v3, v3, v4
  v_lshl_add_u32 v2, v3, 4, v2
  s_lshl_b32 s7, s17, 8
  s_add_u32 s7, s7, s19
  v_add_u32 v120, s7, v2
  v_and_b32 v2, 1, v1
  v_mul_u32_u24 v2, 4640, v2
  v_bfe_u32 v3, v1, 1, 3
  v_lshlrev_b32 v3, 6, v3
  v_sub_u32 v2, v2, v3
  v_lshl_add_u32 v2, v4, 4, v2
  s_add_u32 s7, s7, 17088
  v_add_u32 v121, s7, v2
  v_mov_b32 v20, 0
  v_mov_b32 v21, 0
  v_mov_b32 v22, 0
  v_mov_b32 v23, 0
  v_mov_b32 v24, 0
  v_mov_b32 v25, 0
  v_mov_b32 v26, 0
  v_mov_b32 v27, 0
  v_mov_b32 v28, 0
  v_mov_b32 v29, 0
  v_mov_b32 v30, 0
  v_mov_b32 v31, 0
  v_mov_b32 v32, 0
  v_mov_b32 v33, 0
  v_mov_b32 v34, 0
  v_mov_b32 v35, 0
  v_mov_b32 v36, 0
  v_mov_b32 v37, 0
  v_mov_b32 v38, 0
  v_mov_b32 v39, 0
  v_mov_b32 v40, 0
  v_mov_b32 v41, 0
  v_mov_b32 v42, 0
  v_mov_b32 v43, 0
  v_mov_b32 v44, 0
  v_mov_b32 v45, 0
  v_mov_b32 v46, 0
  v_mov_b32 v47, 0
  v_mov_b32 v48, 0
  v_mov_b32 v49, 0
  v_mov_b32 v50, 0
  v_mov_b32 v51, 0
  s_and_b32 s7, s18, 1
  s_lshl_b32 s7, s7, 4
  s_lshr_b32 s7, s94, s7
  s_and_b32 s7, s7, 0xffff
  s_cmp_eq_u32 s17, 0
  s_cselect_b32 s7, s7, 0
  v_and_b32 v2, 3, v1
  v_lshlrev_b32 v2, 1, v2
  v_bfe_u32 v3, v1, 2, 2
  v_lshl_add_u32 v2, v3, 3, v2
  v_lshl_add_u32 v2, v4, 3, v2
  v_sub_u32 v2, 30, v2
  v_mov_b32 v3, s7
  v_cmp_eq_u32 vcc, 0, v2
  s_nop 1
  v_cndmask_b32 v116, 0, v3, vcc
  v_cmp_eq_u32 vcc, 2, v2
  s_nop 1
  v_cndmask_b32 v117, 0, v3, vcc
  v_cmp_eq_u32 vcc, 4, v2
  s_nop 1
  v_cndmask_b32 v118, 0, v3, vcc
  v_cmp_eq_u32 vcc, 6, v2
  s_nop 1
  v_cndmask_b32 v119, 0, v3, vcc
  s_waitcnt vmcnt(0)
  s_waitcnt lgkmcnt(0)
  s_barrier
  v_mov_b32 v2, 163824
  ds_read_b32 v3, v2
  s_add_u32 m0, s35, 0
  s_add_u32 s3, s36, 0
  buffer_load_dwordx4 v123, s[96:99], s3 offen lds
  s_add_u32 m0, s35, 1024
  s_add_u32 s3, s36, 32768
  buffer_load_dwordx4 v123, s[96:99], s3 offen lds
  s_add_u32 m0, s35, 2048
  s_add_u32 s3, s36, 65536
  buffer_load_dwordx4 v123, s[96:99], s3 offen lds
  s_add_u32 m0, s35, 3072
  s_add_u32 s3, s36, 98304
  buffer_load_dwordx4 v123, s[96:99], s3 offen lds
  s_waitcnt lgkmcnt(0)
  v_readfirstlane_b32 s7, v3
  s_nop 4
  s_cmp_eq_u32 s7, 0
  s_cbranch_scc1 nofb_25
  s_cmp_lg_u32 s101, 0
  s_cbranch_scc1 nofb_25
  s_branch fallback_26
nofb_25:
  s_cmp_lg_u32 s4, 0
  s_cbranch_scc1 pub_29
  s_lshl_b32 s7, s32, 6
  s_add_u32 s7, s7, 17858560
  v_mov_b32 v2, 0
  v_mov_b32 v3, s100
  s_mov_b64 exec, 1
  buffer_store_dword v3, v2, s[28:31], s7 offen sc1
  s_mov_b64 exec, -1
pub_29:
  s_cmp_ge_u32 s4, 4
  s_cbranch_scc1 sp_30
  s_setprio 2
  s_branch sp_31
sp_30:
  s_setprio 1
sp_31:
  ds_read_b128 v[84:87], v121 offset:3584
  ds_read_b128 v[80:83], v120 offset:3584
  ds_read_b128 v[76:79], v120 offset:3072
  ds_read_b128 v[88:91], v121 offset:3072
  ds_read_b128 v[72:75], v120 offset:2560
  ds_read_b128 v[92:95], v121 offset:2560
  ds_read_b128 v[68:71], v120 offset:2048
  ds_read_b128 v[96:99], v121 offset:2048
  s_waitcnt lgkmcnt(6)
  v_mfma_f32_16x16x32_bf16 v[48:51], v[80:83], v[84:87], v[48:51]
  ds_read_b128 v[64:67], v120 offset:1536
  ds_read_b128 v[80:83], v120 offset:3648
  s_waitcnt lgkmcnt(7)
  v_mfma_f32_16x16x32_bf16 v[44:47], v[76:79], v[84:87], v[44:47]
  ds_read_b128 v[100:103], v121 offset:1536
  s_waitcnt vmcnt(3)
  ds_read_b64_tr_b16 v[128:129], v122 offset:0
  ds_read_b64_tr_b16 v[130:131], v122 offset:256
  s_waitcnt lgkmcnt(9)
  v_mfma_f32_16x16x32_bf16 v[48:51], v[76:79], v[88:91], v[48:51]
  ds_read_b128 v[60:63], v120 offset:1024
  ds_read_b128 v[76:79], v120 offset:3136
  s_waitcnt lgkmcnt(10)
  v_mfma_f32_16x16x32_bf16 v[40:43], v[72:75], v[84:87], v[40:43]
  ds_read_b128 v[104:107], v121 offset:1024
  v_mfma_f32_16x16x32_bf16 v[44:47], v[72:75], v[88:91], v[44:47]
  ds_read_b128 v[56:59], v120 offset:512
  s_waitcnt lgkmcnt(4)
  s_add_u32 m0, s35, 0
  s_add_u32 s3, s36, 131072
  buffer_load_dwordx4 v123, s[96:99], s3 offen lds
  v_mfma_f32_16x16x32_bf16 v[48:51], v[72:75], v[92:95], v[48:51]
  ds_read_b128 v[108:111], v121 offset:512
  ds_read_b128 v[72:75], v120 offset:2624
  v_mfma_f32_16x16x32_bf16 v[36:39], v[68:71], v[84:87], v[36:39]
  ds_read_b128 v[52:55], v120 offset:0
  s_waitcnt vmcnt(3)
  ds_read_b64_tr_b16 v[132:133], v122 offset:1024
  ds_read_b64_tr_b16 v[134:135], v122 offset:1280
  v_mfma_f32_16x16x32_bf16 v[40:43], v[68:71], v[88:91], v[40:43]
  ds_read_b128 v[112:115], v121 offset:0
  v_mfma_f32_16x16x32_bf16 v[44:47], v[68:71], v[92:95], v[44:47]
  v_mfma_f32_16x16x32_bf16 v[48:51], v[68:71], v[96:99], v[48:51]
  s_waitcnt lgkmcnt(1)
  s_add_u32 m0, s35, 1024
  s_add_u32 s3, s36, 163840
  buffer_load_dwordx4 v123, s[96:99], s3 offen lds
  ds_read_b128 v[68:71], v120 offset:2112
  v_mfma_f32_16x16x32_bf16 v[32:35], v[64:67], v[84:87], v[32:35]
  v_mfma_f32_16x16x32_bf16 v[36:39], v[64:67], v[88:91], v[36:39]
  s_waitcnt vmcnt(3)
  ds_read_b64_tr_b16 v[136:137], v122 offset:2048
  ds_read_b64_tr_b16 v[138:139], v122 offset:2304
  v_mfma_f32_16x16x32_bf16 v[40:43], v[64:67], v[92:95], v[40:43]
  v_mfma_f32_16x16x32_bf16 v[44:47], v[64:67], v[96:99], v[44:47]
  v_mfma_f32_16x16x32_bf16 v[48:51], v[64:67], v[100:103], v[48:51]
  s_waitcnt lgkmcnt(0)
  s_add_u32 m0, s35, 2048
  s_add_u32 s3, s36, 196608
  buffer_load_dwordx4 v123, s[96:99], s3 offen lds
  ds_read_b128 v[64:67], v120 offset:1600
  v_mfma_f32_16x16x32_bf16 v[28:31], v[60:63], v[84:87], v[28:31]
  v_mfma_f32_16x16x32_bf16 v[32:35], v[60:63], v[88:91], v[32:35]
  s_waitcnt vmcnt(3)
  ds_read_b64_tr_b16 v[140:141], v122 offset:3072
  ds_read_b64_tr_b16 v[142:143], v122 offset:3328
  v_mfma_f32_16x16x32_bf16 v[36:39], v[60:63], v[92:95], v[36:39]
  v_mfma_f32_16x16x32_bf16 v[40:43], v[60:63], v[96:99], v[40:43]
  v_mfma_f32_16x16x32_bf16 v[44:47], v[60:63], v[100:103], v[44:47]
  s_waitcnt lgkmcnt(0)
  s_add_u32 m0, s35, 3072
  s_add_u32 s3, s36, 229376
  buffer_load_dwordx4 v123, s[96:99], s3 offen lds
  v_mfma_f32_16x16x32_bf16 v[48:51], v[60:63], v[104:107], v[48:51]
  s_waitcnt vmcnt(3)
  ds_read_b64_tr_b16 v[144:145], v122 offset:0
  ds_read_b64_tr_b16 v[146:147], v122 offset:256
  ds_read_b128 v[60:63], v120 offset:1088
  v_mfma_f32_16x16x32_bf16 v[24:27], v[56:59], v[84:87], v[24:27]
  v_mfma_f32_16x16x32_bf16 v[28:31], v[56:59], v[88:91], v[28:31]
  v_mfma_f32_16x16x32_bf16 v[32:35], v[56:59], v[92:95], v[32:35]
  s_waitcnt lgkmcnt(1)
  s_add_u32 m0, s35, 0
  s_add_u32 s3, s36, 262144
  buffer_load_dwordx4 v123, s[96:99], s3 offen lds
  v_mfma_f32_16x16x32_bf16 v[36:39], v[56:59], v[96:99], v[36:39]
  v_mfma_f32_16x16x32_bf16 v[40:43], v[56:59], v[100:103], v[40:43]
  s_waitcnt vmcnt(3)
  ds_read_b64_tr_b16 v[148:149], v122 offset:1024
  ds_read_b64_tr_b16 v[150:151], v122 offset:1280
  v_mfma_f32_16x16x32_bf16 v[44:47], v[56:59], v[104:107], v[44:47]
  v_mfma_f32_16x16x32_bf16 v[48:51], v[56:59], v[108:111], v[48:51]
  ds_read_b128 v[56:59], v120 offset:576
  v_mfma_f32_16x16x32_bf16 v[20:23], v[52:55], v[84:87], v[20:23]
  v_mfma_f32_16x16x32_bf16 v[20:23], v[116:119], v[84:87], v[20:23]
  ds_read_b128 v[84:87], v121 offset:3648
  s_waitcnt lgkmcnt(2)
  s_add_u32 m0, s35, 1024
  s_add_u32 s3, s36, 294912
  buffer_load_dwordx4 v123, s[96:99], s3 offen lds
  v_mfma_f32_16x16x32_bf16 v[24:27], v[52:55], v[88:91], v[24:27]
  v_mfma_f32_16x16x32_bf16 v[24:27], v[116:119], v[88:91], v[24:27]
  ds_read_b128 v[88:91], v121 offset:3136
  s_waitcnt vmcnt(3)
  ds_read_b64_tr_b16 v[152:153], v122 offset:2048
  ds_read_b64_tr_b16 v[154:155], v122 offset:2304
  v_mfma_f32_16x16x32_bf16 v[28:31], v[52:55], v[92:95], v[28:31]
  v_mfma_f32_16x16x32_bf16 v[28:31], v[116:119], v[92:95], v[28:31]
  ds_read_b128 v[92:95], v121 offset:2624
  v_mfma_f32_16x16x32_bf16 v[32:35], v[52:55], v[96:99], v[32:35]
  v_mfma_f32_16x16x32_bf16 v[32:35], v[116:119], v[96:99], v[32:35]
  ds_read_b128 v[96:99], v121 offset:2112
  s_waitcnt lgkmcnt(2)
  s_add_u32 m0, s35, 2048
  s_add_u32 s3, s36, 327680
  buffer_load_dwordx4 v123, s[96:99], s3 offen lds
  s_waitcnt vmcnt(3)
  ds_read_b64_tr_b16 v[156:157], v122 offset:3072
  ds_read_b64_tr_b16 v[158:159], v122 offset:3328
  v_mfma_f32_16x16x32_bf16 v[36:39], v[52:55], v[100:103], v[36:39]
  v_mfma_f32_16x16x32_bf16 v[36:39], v[116:119], v[100:103], v[36:39]
  ds_read_b128 v[100:103], v121 offset:1600
  v_mfma_f32_16x16x32_bf16 v[40:43], v[52:55], v[104:107], v[40:43]
  v_mfma_f32_16x16x32_bf16 v[40:43], v[116:119], v[104:107], v[40:43]
  ds_read_b128 v[104:107], v121 offset:1088
  s_waitcnt lgkmcnt(2)
  s_add_u32 m0, s35, 3072
  s_add_u32 s3, s36, 360448
  buffer_load_dwordx4 v123, s[96:99], s3 offen lds
  s_waitcnt vmcnt(3)
  ds_read_b64_tr_b16 v[160:161], v122 offset:0
  ds_read_b64_tr_b16 v[162:163], v122 offset:256
  v_mfma_f32_16x16x32_bf16 v[44:47], v[52:55], v[108:111], v[44:47]
  v_mfma_f32_16x16x32_bf16 v[44:47], v[116:119], v[108:111], v[44:47]
  ds_read_b128 v[108:111], v121 offset:576
  v_mfma_f32_16x16x32_bf16 v[48:51], v[52:55], v[112:115], v[48:51]
  v_mfma_f32_16x16x32_bf16 v[48:51], v[116:119], v[112:115], v[48:51]
  ds_read_b128 v[112:115], v121 offset:64
  s_waitcnt lgkmcnt(2)
  s_add_u32 m0, s35, 0
  s_add_u32 s3, s36, 393216
  buffer_load_dwordx4 v123, s[96:99], s3 offen lds
  ds_read_b128 v[52:55], v120 offset:64
  v_mfma_f32_16x16x32_bf16 v[48:51], v[80:83], v[84:87], v[48:51]
  s_waitcnt vmcnt(3)
  ds_read_b64_tr_b16 v[164:165], v122 offset:1024
  ds_read_b64_tr_b16 v[166:167], v122 offset:1280
  ds_read_b128 v[80:83], v120 offset:3712
  v_mfma_f32_16x16x32_bf16 v[44:47], v[76:79], v[84:87], v[44:47]
  v_mfma_f32_16x16x32_bf16 v[48:51], v[76:79], v[88:91], v[48:51]
  ds_read_b128 v[76:79], v120 offset:3200
  v_mfma_f32_16x16x32_bf16 v[40:43], v[72:75], v[84:87], v[40:43]
  s_waitcnt lgkmcnt(2)
  s_add_u32 m0, s35, 1024
  s_add_u32 s3, s36, 425984
  buffer_load_dwordx4 v123, s[96:99], s3 offen lds
  v_mfma_f32_16x16x32_bf16 v[44:47], v[72:75], v[88:91], v[44:47]
  s_waitcnt vmcnt(3)
  ds_read_b64_tr_b16 v[168:169], v122 offset:2048
  ds_read_b64_tr_b16 v[170:171], v122 offset:2304
  v_mfma_f32_16x16x32_bf16 v[48:51], v[72:75], v[92:95], v[48:51]
  ds_read_b128 v[72:75], v120 offset:2688
  v_mfma_f32_16x16x32_bf16 v[36:39], v[68:71], v[84:87], v[36:39]
  v_mfma_f32_16x16x32_bf16 v[40:43], v[68:71], v[88:91], v[40:43]
  s_waitcnt lgkmcnt(1)
  s_add_u32 m0, s35, 2048
  s_add_u32 s3, s36, 458752
  buffer_load_dwordx4 v123, s[96:99], s3 offen lds
  v_mfma_f32_16x16x32_bf16 v[44:47], v[68:71], v[92:95], v[44:47]
  v_mfma_f32_16x16x32_bf16 v[48:51], v[68:71], v[96:99], v[48:51]
  s_waitcnt vmcnt(3)
  ds_read_b64_tr_b16 v[172:173], v122 offset:3072
  ds_read_b64_tr_b16 v[174:175], v122 offset:3328
  ds_read_b128 v[68:71], v120 offset:2176
  v_mfma_f32_16x16x32_bf16 v[32:35], v[64:67], v[84:87], v[32:35]
  v_mfma_f32_16x16x32_bf16 v[36:39], v[64:67], v[88:91], v[36:39]
  v_mfma_f32_16x16x32_bf16 v[40:43], v[64:67], v[92:95], v[40:43]
  s_waitcnt lgkmcnt(1)
  s_add_u32 m0, s35, 3072
  s_add_u32 s3, s36, 491520
  buffer_load_dwordx4 v123, s[96:99], s3 offen lds
  v_mfma_f32_16x16x32_bf16 v[44:47], v[64:67], v[96:99], v[44:47]
  v_mfma_f32_16x16x32_bf16 v[48:51], v[64:67], v[100:103], v[48:51]
  s_waitcnt vmcnt(3)
  ds_read_b64_tr_b16 v[176:177], v122 offset:0
  ds_read_b64_tr_b16 v[178:179], v122 offset:256
  ds_read_b128 v[64:67], v120 offset:1664
  v_mfma_f32_16x16x32_bf16 v[28:31], v[60:63], v[84:87], v[28:31]
  v_mfma_f32_16x16x32_bf16 v[32:35], v[60:63], v[88:91], v[32:35]
  v_mfma_f32_16x16x32_bf16 v[36:39], v[60:63], v[92:95], v[36:39]
  s_waitcnt lgkmcnt(1)
  s_add_u32 m0, s35, 0
  s_add_u32 s3, s36, 524288
  buffer_load_dwordx4 v123, s[96:99], s3 offen lds
  v_mfma_f32_16x16x32_bf16 v[40:43], v[60:63], v[96:99], v[40:43]
  s_waitcnt vmcnt(3)
  ds_read_b64_tr_b16 v[180:181], v122 offset:1024
  ds_read_b64_tr_b16 v[182:183], v122 offset:1280
  v_mfma_f32_16x16x32_bf16 v[44:47], v[60:63], v[100:103], v[44:47]
  v_mfma_f32_16x16x32_bf16 v[48:51], v[60:63], v[104:107], v[48:51]
  ds_read_b128 v[60:63], v120 offset:1152
  v_mfma_f32_16x16x32_bf16 v[24:27], v[56:59], v[84:87], v[24:27]
  s_waitcnt lgkmcnt(1)
  s_add_u32 m0, s35, 1024
  s_add_u32 s3, s36, 557056
  buffer_load_dwordx4 v123, s[96:99], s3 offen lds
  v_mfma_f32_16x16x32_bf16 v[28:31], v[56:59], v[88:91], v[28:31]
  v_mfma_f32_16x16x32_bf16 v[32:35], v[56:59], v[92:95], v[32:35]
  s_waitcnt vmcnt(3)
  ds_read_b64_tr_b16 v[184:185], v122 offset:2048
  ds_read_b64_tr_b16 v[186:187], v122 offset:2304
  v_mfma_f32_16x16x32_bf16 v[36:39], v[56:59], v[96:99], v[36:39]
  v_mfma_f32_16x16x32_bf16 v[40:43], v[56:59], v[100:103], v[40:43]
  v_mfma_f32_16x16x32_bf16 v[44:47], v[56:59], v[104:107], v[44:47]
  s_waitcnt lgkmcnt(0)
  s_add_u32 m0, s35, 2048
  s_add_u32 s3, s36, 589824
  buffer_load_dwordx4 v123, s[96:99], s3 offen lds
  v_mfma_f32_16x16x32_bf16 v[48:51], v[56:59], v[108:111], v[48:51]
  ds_read_b128 v[56:59], v120 offset:640
  v_mfma_f32_16x16x32_bf16 v[20:23], v[52:55], v[84:87], v[20:23]
  ds_read_b128 v[84:87], v121 offset:3712
  s_waitcnt vmcnt(3)
  ds_read_b64_tr_b16 v[188:189], v122 offset:3072
  ds_read_b64_tr_b16 v[190:191], v122 offset:3328
  v_mfma_f32_16x16x32_bf16 v[24:27], v[52:55], v[88:91], v[24:27]
  ds_read_b128 v[88:91], v121 offset:3200
  v_mfma_f32_16x16x32_bf16 v[28:31], v[52:55], v[92:95], v[28:31]
  ds_read_b128 v[92:95], v121 offset:2688
  v_mfma_f32_16x16x32_bf16 v[32:35], v[52:55], v[96:99], v[32:35]
  ds_read_b128 v[96:99], v121 offset:2176
  s_waitcnt lgkmcnt(3)
  s_add_u32 m0, s35, 3072
  s_add_u32 s3, s36, 622592
  buffer_load_dwordx4 v123, s[96:99], s3 offen lds
  v_mfma_f32_16x16x32_bf16 v[36:39], v[52:55], v[100:103], v[36:39]
  ds_read_b128 v[100:103], v121 offset:1664
  s_waitcnt vmcnt(3)
  ds_read_b64_tr_b16 v[192:193], v122 offset:0
  ds_read_b64_tr_b16 v[194:195], v122 offset:256
  v_mfma_f32_16x16x32_bf16 v[40:43], v[52:55], v[104:107], v[40:43]
  ds_read_b128 v[104:107], v121 offset:1152
  v_mfma_f32_16x16x32_bf16 v[44:47], v[52:55], v[108:111], v[44:47]
  ds_read_b128 v[108:111], v121 offset:640
  v_mfma_f32_16x16x32_bf16 v[48:51], v[52:55], v[112:115], v[48:51]
  ds_read_b128 v[112:115], v121 offset:128
  s_waitcnt lgkmcnt(3)
  s_add_u32 m0, s35, 0
  s_add_u32 s3, s36, 655360
  buffer_load_dwordx4 v123, s[96:99], s3 offen lds
  ds_read_b128 v[52:55], v120 offset:128
  buffer_load_dword v11, v10, s[28:31], s95 offen sc1
  v_mfma_f32_16x16x32_bf16 v[48:51], v[80:83], v[84:87], v[48:51]
  ds_read_b128 v[80:83], v120 offset:3776
  v_mfma_f32_16x16x32_bf16 v[44:47], v[76:79], v[84:87], v[44:47]
  s_waitcnt vmcnt(4)
  ds_read_b64_tr_b16 v[196:197], v122 offset:1024
  ds_read_b64_tr_b16 v[198:199], v122 offset:1280
  v_mfma_f32_16x16x32_bf16 v[48:51], v[76:79], v[88:91], v[48:51]
  ds_read_b128 v[76:79], v120 offset:3264
  v_mfma_f32_16x16x32_bf16 v[40:43], v[72:75], v[84:87], v[40:43]
  v_mfma_f32_16x16x32_bf16 v[44:47], v[72:75], v[88:91], v[44:47]
  s_waitcnt lgkmcnt(1)
  s_add_u32 m0, s35, 1024
  s_add_u32 s3, s36, 688128
  buffer_load_dwordx4 v123, s[96:99], s3 offen lds
  v_mfma_f32_16x16x32_bf16 v[48:51], v[72:75], v[92:95], v[48:51]
  ds_read_b128 v[72:75], v120 offset:2752
  v_mfma_f32_16x16x32_bf16 v[36:39], v[68:71], v[84:87], v[36:39]
  s_waitcnt vmcnt(4)
  ds_read_b64_tr_b16 v[200:201], v122 offset:2048
  ds_read_b64_tr_b16 v[202:203], v122 offset:2304
  v_mfma_f32_16x16x32_bf16 v[40:43], v[68:71], v[88:91], v[40:43]
  v_mfma_f32_16x16x32_bf16 v[44:47], v[68:71], v[92:95], v[44:47]
  v_mfma_f32_16x16x32_bf16 v[48:51], v[68:71], v[96:99], v[48:51]
  s_waitcnt lgkmcnt(0)
  s_add_u32 m0, s35, 2048
  s_add_u32 s3, s36, 720896
  buffer_load_dwordx4 v123, s[96:99], s3 offen lds
  ds_read_b128 v[68:71], v120 offset:2240
  v_mfma_f32_16x16x32_bf16 v[32:35], v[64:67], v[84:87], v[32:35]
  s_waitcnt vmcnt(4)
  ds_read_b64_tr_b16 v[204:205], v122 offset:3072
  ds_read_b64_tr_b16 v[206:207], v122 offset:3328
  v_mfma_f32_16x16x32_bf16 v[36:39], v[64:67], v[88:91], v[36:39]
  v_mfma_f32_16x16x32_bf16 v[40:43], v[64:67], v[92:95], v[40:43]
  v_mfma_f32_16x16x32_bf16 v[44:47], v[64:67], v[96:99], v[44:47]
  s_waitcnt lgkmcnt(0)
  s_add_u32 m0, s35, 3072
  s_add_u32 s3, s36, 753664
  buffer_load_dwordx4 v123, s[96:99], s3 offen lds
  v_mfma_f32_16x16x32_bf16 v[48:51], v[64:67], v[100:103], v[48:51]
  ds_read_b128 v[64:67], v120 offset:1728
  v_mfma_f32_16x16x32_bf16 v[28:31], v[60:63], v[84:87], v[28:31]
  s_waitcnt vmcnt(4)
  ds_read_b64_tr_b16 v[208:209], v122 offset:0
  ds_read_b64_tr_b16 v[210:211], v122 offset:256
  v_mfma_f32_16x16x32_bf16 v[32:35], v[60:63], v[88:91], v[32:35]
  v_mfma_f32_16x16x32_bf16 v[36:39], v[60:63], v[92:95], v[36:39]
  v_mfma_f32_16x16x32_bf16 v[40:43], v[60:63], v[96:99], v[40:43]
  s_waitcnt lgkmcnt(0)
  s_add_u32 m0, s35, 0
  s_add_u32 s3, s36, 786432
  buffer_load_dwordx4 v123, s[96:99], s3 offen lds
  v_mfma_f32_16x16x32_bf16 v[44:47], v[60:63], v[100:103], v[44:47]
  v_mfma_f32_16x16x32_bf16 v[48:51], v[60:63], v[104:107], v[48:51]
  s_waitcnt vmcnt(3)
  ds_read_b64_tr_b16 v[212:213], v122 offset:1024
  ds_read_b64_tr_b16 v[214:215], v122 offset:1280
  ds_read_b128 v[60:63], v120 offset:1216
  v_mfma_f32_16x16x32_bf16 v[24:27], v[56:59], v[84:87], v[24:27]
  v_mfma_f32_16x16x32_bf16 v[28:31], v[56:59], v[88:91], v[28:31]
  v_mfma_f32_16x16x32_bf16 v[32:35], v[56:59], v[92:95], v[32:35]
  s_waitcnt lgkmcnt(1)
  s_add_u32 m0, s35, 1024
  s_add_u32 s3, s36, 819200
  buffer_load_dwordx4 v123, s[96:99], s3 offen lds
  v_mfma_f32_16x16x32_bf16 v[36:39], v[56:59], v[96:99], v[36:39]
  s_waitcnt vmcnt(3)
  ds_read_b64_tr_b16 v[216:217], v122 offset:2048
  ds_read_b64_tr_b16 v[218:219], v122 offset:2304
  v_mfma_f32_16x16x32_bf16 v[40:43], v[56:59], v[100:103], v[40:43]
  v_mfma_f32_16x16x32_bf16 v[44:47], v[56:59], v[104:107], v[44:47]
  v_mfma_f32_16x16x32_bf16 v[48:51], v[56:59], v[108:111], v[48:51]
  s_waitcnt lgkmcnt(0)
  s_add_u32 m0, s35, 2048
  s_add_u32 s3, s36, 851968
  buffer_load_dwordx4 v123, s[96:99], s3 offen lds
  ds_read_b128 v[56:59], v120 offset:704
  v_mfma_f32_16x16x32_bf16 v[20:23], v[52:55], v[84:87], v[20:23]
  ds_read_b128 v[84:87], v121 offset:3776
  v_mfma_f32_16x16x32_bf16 v[24:27], v[52:55], v[88:91], v[24:27]
  ds_read_b128 v[88:91], v121 offset:3264
  s_waitcnt vmcnt(3)
  ds_read_b64_tr_b16 v[220:221], v122 offset:3072
  ds_read_b64_tr_b16 v[222:223], v122 offset:3328
  v_mfma_f32_16x16x32_bf16 v[28:31], v[52:55], v[92:95], v[28:31]
  ds_read_b128 v[92:95], v121 offset:2752
  v_mfma_f32_16x16x32_bf16 v[32:35], v[52:55], v[96:99], v[32:35]
  ds_read_b128 v[96:99], v121 offset:2240
  v_mfma_f32_16x16x32_bf16 v[36:39], v[52:55], v[100:103], v[36:39]
  ds_read_b128 v[100:103], v121 offset:1728
  s_waitcnt lgkmcnt(3)
  s_add_u32 m0, s35, 3072
  s_add_u32 s3, s36, 884736
  buffer_load_dwordx4 v123, s[96:99], s3 offen lds
  v_mfma_f32_16x16x32_bf16 v[40:43], v[52:55], v[104:107], v[40:43]
  ds_read_b128 v[104:107], v121 offset:1216
  v_mfma_f32_16x16x32_bf16 v[44:47], v[52:55], v[108:111], v[44:47]
  ds_read_b128 v[108:111], v121 offset:704
  s_waitcnt vmcnt(3)
  ds_read_b64_tr_b16 v[224:225], v122 offset:0
  ds_read_b64_tr_b16 v[226:227], v122 offset:256
  v_mfma_f32_16x16x32_bf16 v[48:51], v[52:55], v[112:115], v[48:51]
  ds_read_b128 v[112:115], v121 offset:192
  ds_read_b128 v[52:55], v120 offset:192
  s_cmp_ge_u32 s4, 4
  s_cbranch_scc1 sp_32
  s_setprio 0
  s_branch sp_33
sp_32:
  s_setprio 1
sp_33:
  v_mfma_f32_16x16x32_bf16 v[48:51], v[80:83], v[84:87], v[48:51]
  v_mfma_f32_16x16x32_bf16 v[44:47], v[76:79], v[84:87], v[44:47]
  s_waitcnt lgkmcnt(2)
  s_add_u32 m0, s35, 0
  s_add_u32 s3, s36, 917504
  buffer_load_dwordx4 v123, s[96:99], s3 offen lds
  v_mfma_f32_16x16x32_bf16 v[48:51], v[76:79], v[88:91], v[48:51]
  s_waitcnt vmcnt(3)
  ds_read_b64_tr_b16 v[228:229], v122 offset:1024
  ds_read_b64_tr_b16 v[230:231], v122 offset:1280
  v_mfma_f32_16x16x32_bf16 v[40:43], v[72:75], v[84:87], v[40:43]
  v_mfma_f32_16x16x32_bf16 v[44:47], v[72:75], v[88:91], v[44:47]
  v_mfma_f32_16x16x32_bf16 v[48:51], v[72:75], v[92:95], v[48:51]
  s_waitcnt lgkmcnt(0)
  s_add_u32 m0, s35, 1024
  s_add_u32 s3, s36, 950272
  buffer_load_dwordx4 v123, s[96:99], s3 offen lds
  v_mfma_f32_16x16x32_bf16 v[36:39], v[68:71], v[84:87], v[36:39]
  v_mfma_f32_16x16x32_bf16 v[40:43], v[68:71], v[88:91], v[40:43]
  s_waitcnt vmcnt(3)
  ds_read_b64_tr_b16 v[232:233], v122 offset:2048
  ds_read_b64_tr_b16 v[234:235], v122 offset:2304
  v_mfma_f32_16x16x32_bf16 v[44:47], v[68:71], v[92:95], v[44:47]
  v_mfma_f32_16x16x32_bf16 v[48:51], v[68:71], v[96:99], v[48:51]
  v_mfma_f32_16x16x32_bf16 v[32:35], v[64:67], v[84:87], v[32:35]
  s_waitcnt lgkmcnt(0)
  s_add_u32 m0, s35, 2048
  s_add_u32 s3, s36, 983040
  buffer_load_dwordx4 v123, s[96:99], s3 offen lds
  v_mfma_f32_16x16x32_bf16 v[36:39], v[64:67], v[88:91], v[36:39]
  v_mfma_f32_16x16x32_bf16 v[40:43], v[64:67], v[92:95], v[40:43]
  s_waitcnt vmcnt(3)
  ds_read_b64_tr_b16 v[236:237], v122 offset:3072
  ds_read_b64_tr_b16 v[238:239], v122 offset:3328
  v_mfma_f32_16x16x32_bf16 v[44:47], v[64:67], v[96:99], v[44:47]
  v_mfma_f32_16x16x32_bf16 v[48:51], v[64:67], v[100:103], v[48:51]
  v_mfma_f32_16x16x32_bf16 v[28:31], v[60:63], v[84:87], v[28:31]
  s_waitcnt lgkmcnt(0)
  s_add_u32 m0, s35, 3072
  s_add_u32 s3, s36, 1015808
  buffer_load_dwordx4 v123, s[96:99], s3 offen lds
  v_mfma_f32_16x16x32_bf16 v[32:35], v[60:63], v[88:91], v[32:35]
  s_waitcnt vmcnt(3)
  ds_read_b64_tr_b16 v[240:241], v122 offset:0
  ds_read_b64_tr_b16 v[242:243], v122 offset:256
  v_mfma_f32_16x16x32_bf16 v[36:39], v[60:63], v[92:95], v[36:39]
  v_mfma_f32_16x16x32_bf16 v[40:43], v[60:63], v[96:99], v[40:43]
  v_mfma_f32_16x16x32_bf16 v[44:47], v[60:63], v[100:103], v[44:47]
  v_mfma_f32_16x16x32_bf16 v[48:51], v[60:63], v[104:107], v[48:51]
  v_mfma_f32_16x16x32_bf16 v[24:27], v[56:59], v[84:87], v[24:27]
  s_waitcnt vmcnt(2)
  ds_read_b64_tr_b16 v[244:245], v122 offset:1024
  ds_read_b64_tr_b16 v[246:247], v122 offset:1280
  v_mfma_f32_16x16x32_bf16 v[28:31], v[56:59], v[88:91], v[28:31]
  v_mfma_f32_16x16x32_bf16 v[32:35], v[56:59], v[92:95], v[32:35]
  v_mfma_f32_16x16x32_bf16 v[36:39], v[56:59], v[96:99], v[36:39]
  v_mfma_f32_16x16x32_bf16 v[40:43], v[56:59], v[100:103], v[40:43]
  v_mfma_f32_16x16x32_bf16 v[44:47], v[56:59], v[104:107], v[44:47]
  s_waitcnt vmcnt(1)
  ds_read_b64_tr_b16 v[248:249], v122 offset:2048
  ds_read_b64_tr_b16 v[250:251], v122 offset:2304
  v_mfma_f32_16x16x32_bf16 v[48:51], v[56:59], v[108:111], v[48:51]
  v_mfma_f32_16x16x32_bf16 v[20:23], v[52:55], v[84:87], v[20:23]
  v_mfma_f32_16x16x32_bf16 v[24:27], v[52:55], v[88:91], v[24:27]
  v_mfma_f32_16x16x32_bf16 v[28:31], v[52:55], v[92:95], v[28:31]
  s_waitcnt vmcnt(0)
  ds_read_b64_tr_b16 v[252:253], v122 offset:3072
  ds_read_b64_tr_b16 v[254:255], v122 offset:3328
  v_mfma_f32_16x16x32_bf16 v[32:35], v[52:55], v[96:99], v[32:35]
  v_mfma_f32_16x16x32_bf16 v[36:39], v[52:55], v[100:103], v[36:39]
  v_mfma_f32_16x16x32_bf16 v[40:43], v[52:55], v[104:107], v[40:43]
  v_mfma_f32_16x16x32_bf16 v[44:47], v[52:55], v[108:111], v[44:47]
  v_mfma_f32_16x16x32_bf16 v[48:51], v[52:55], v[112:115], v[48:51]
  s_setprio 0
  s_nop 7
  s_waitcnt lgkmcnt(0)
  v_lshlrev_b32 v2, 4, v1
  v_add_u32 v3, s35, v2
  s_cmp_lg_u32 s17, 0
  s_cbranch_scc1 cvh_34
  ds_write_b128 v3, v[36:39] offset:0
  ds_write_b128 v3, v[40:43] offset:1024
  ds_write_b128 v3, v[44:47] offset:2048
  ds_write_b128 v3, v[48:51] offset:3072
  s_branch cvj_35
cvh_34:
  ds_write_b128 v3, v[20:23] offset:0
  ds_write_b128 v3, v[24:27] offset:1024
  ds_write_b128 v3, v[28:31] offset:2048
  ds_write_b128 v3, v[32:35] offset:3072
  s_nop 1
  v_mov_b32 v20, v36
  v_mov_b32 v21, v37
  v_mov_b32 v22, v38
  v_mov_b32 v23, v39
  v_mov_b32 v24, v40
  v_mov_b32 v25, v41
  v_mov_b32 v26, v42
  v_mov_b32 v27, v43
  v_mov_b32 v28, v44
  v_mov_b32 v29, v45
  v_mov_b32 v30, v46
  v_mov_b32 v31, v47
  v_mov_b32 v32, v48
  v_mov_b32 v33, v49
  v_mov_b32 v34, v50
  v_mov_b32 v35, v51
cvj_35:
  v_xor_b32 v115, 4096, v3
  v_and_b32 v2, 1, v1
  v_cmp_eq_u32 s[62:63], 1, v2
  v_lshlrev_b32 v2, 3, v2
  v_bfe_u32 v4, v1, 1, 3
  v_lshl_add_u32 v2, v4, 6, v2
  v_lshrrev_b32 v4, 4, v1
  v_lshl_add_u32 v114, v4, 4, v2
  s_waitcnt vmcnt(11)
  s_mov_b32 s3, 0
fcp_37:
  v_cmp_ne_u32 vcc, s100, v11
  s_nop 4
  s_cmp_eq_u64 vcc, 0
  s_cbranch_scc1 fc_36
  s_add_u32 s3, s3, 1
  s_cmp_ge_u32 s3, 200000
  s_cbranch_scc1 fc_36
  s_sleep 1
  buffer_load_dword v11, v10, s[28:31], s95 offen sc1
  s_waitcnt vmcnt(0)
  s_branch fcp_37
fc_36:
  s_waitcnt lgkmcnt(0)
  s_barrier
  ds_read_b128 v[52:55], v115 offset:0
  ds_read_b128 v[56:59], v115 offset:1024
  ds_read_b128 v[60:63], v115 offset:2048
  ds_read_b128 v[64:67], v115 offset:3072
  s_add_u32 m0, s60, 0
  s_add_u32 s3, s61, 0
  buffer_load_dwordx4 v124, s[8:11], s3 offen lds
  s_add_u32 m0, s60, 1024
  s_add_u32 s3, s61, 0
  buffer_load_dwordx4 v125, s[8:11], s3 offen lds
  s_add_u32 m0, s60, 2048
  s_add_u32 s3, s61, 0
  buffer_load_dwordx4 v126, s[8:11], s3 offen lds
  s_add_u32 m0, s60, 3072
  s_add_u32 s3, s61, 0
  buffer_load_dwordx4 v127, s[8:11], s3 offen lds
  s_waitcnt lgkmcnt(3)
  v_add_f32 v20, v20, v52
  v_add_f32 v21, v21, v53
  v_add_f32 v22, v22, v54
  v_add_f32 v23, v23, v55
  s_waitcnt lgkmcnt(2)
  v_add_f32 v24, v24, v56
  v_add_f32 v25, v25, v57
  v_add_f32 v26, v26, v58
  v_add_f32 v27, v27, v59
  s_waitcnt lgkmcnt(1)
  v_add_f32 v28, v28, v60
  v_add_f32 v29, v29, v61
  v_add_f32 v30, v30, v62
  v_add_f32 v31, v31, v63
  s_waitcnt lgkmcnt(0)
  v_add_f32 v32, v32, v64
  v_add_f32 v33, v33, v65
  v_add_f32 v34, v34, v66
  v_add_f32 v35, v35, v67
  v_cndmask_b32 v84, v22, v20, s[62:63]
  v_cndmask_b32 v85, v23, v21, s[62:63]
  v_cndmask_b32 v90, v26, v24, s[62:63]
  v_cndmask_b32 v91, v27, v25, s[62:63]
  v_cndmask_b32 v96, v30, v28, s[62:63]
  v_cndmask_b32 v97, v31, v29, s[62:63]
  v_cndmask_b32 v102, v34, v32, s[62:63]
  v_cndmask_b32 v103, v35, v33, s[62:63]
  v_mov_b32_dpp v86, v84 quad_perm:[1,0,3,2] row_mask:0xf bank_mask:0xf
  v_mov_b32_dpp v87, v85 quad_perm:[1,0,3,2] row_mask:0xf bank_mask:0xf
  v_mov_b32_dpp v92, v90 quad_perm:[1,0,3,2] row_mask:0xf bank_mask:0xf
  v_mov_b32_dpp v93, v91 quad_perm:[1,0,3,2] row_mask:0xf bank_mask:0xf
  v_mov_b32_dpp v98, v96 quad_perm:[1,0,3,2] row_mask:0xf bank_mask:0xf
  v_mov_b32_dpp v99, v97 quad_perm:[1,0,3,2] row_mask:0xf bank_mask:0xf
  v_mov_b32_dpp v104, v102 quad_perm:[1,0,3,2] row_mask:0xf bank_mask:0xf
  v_mov_b32_dpp v105, v103 quad_perm:[1,0,3,2] row_mask:0xf bank_mask:0xf
  v_and_b32 v115, 0xfffff000, v115
  v_add_u32 v114, v115, v114
  v_cndmask_b32 v84, v20, v86, s[62:63]
  v_cndmask_b32 v85, v86, v22, s[62:63]
  v_cndmask_b32 v20, v21, v87, s[62:63]
  v_cndmask_b32 v22, v87, v23, s[62:63]
  v_cvt_pk_bf16_f32 v88, v84, v85
  v_cvt_pk_bf16_f32 v89, v20, v22
  ds_write_b64 v114, v[88:89] offset:0
  v_cndmask_b32 v90, v24, v92, s[62:63]
  v_cndmask_b32 v91, v92, v26, s[62:63]
  v_cndmask_b32 v24, v25, v93, s[62:63]
  v_cndmask_b32 v26, v93, v27, s[62:63]
  v_cvt_pk_bf16_f32 v94, v90, v91
  v_cvt_pk_bf16_f32 v95, v24, v26
  ds_write_b64 v114, v[94:95] offset:512
  v_cndmask_b32 v96, v28, v98, s[62:63]
  v_cndmask_b32 v97, v98, v30, s[62:63]
  v_cndmask_b32 v28, v29, v99, s[62:63]
  v_cndmask_b32 v30, v99, v31, s[62:63]
  v_cvt_pk_bf16_f32 v100, v96, v97
  v_cvt_pk_bf16_f32 v101, v28, v30
  ds_write_b64 v114, v[100:101] offset:1024
  v_cndmask_b32 v102, v32, v104, s[62:63]
  v_cndmask_b32 v103, v104, v34, s[62:63]
  v_cndmask_b32 v32, v33, v105, s[62:63]
  v_cndmask_b32 v34, v105, v35, s[62:63]
  v_cvt_pk_bf16_f32 v106, v102, v103
  v_cvt_pk_bf16_f32 v107, v32, v34
  ds_write_b64 v114, v[106:107] offset:1536
  v_lshlrev_b32 v2, 4, v1
  v_add_u32 v115, v115, v2
  s_lshl_b32 s7, s18, 12
  s_lshl_b32 s3, s17, 11
  s_add_u32 s7, s7, s3
  s_add_u32 s7, s7, 12582912
  s_waitcnt lgkmcnt(0)
  ds_read_b128 v[52:55], v115
  ds_read_b128 v[56:59], v115 offset:1024
  s_waitcnt lgkmcnt(1)
  buffer_store_dwordx4 v[52:55], v2, s[28:31], s7 offen sc1
  s_waitcnt lgkmcnt(0)
  buffer_store_dwordx4 v[56:59], v2, s[28:31], s7 offen offset:1024 sc1
  s_add_u32 m0, s60, 16384
  s_add_u32 s3, s61, 256
  buffer_load_dwordx4 v124, s[8:11], s3 offen lds
  s_add_u32 m0, s60, 17408
  s_add_u32 s3, s61, 256
  buffer_load_dwordx4 v125, s[8:11], s3 offen lds
  s_add_u32 m0, s60, 18432
  s_add_u32 s3, s61, 256
  buffer_load_dwordx4 v126, s[8:11], s3 offen lds
  s_add_u32 m0, s60, 19456
  s_add_u32 s3, s61, 256
  buffer_load_dwordx4 v127, s[8:11], s3 offen lds
  s_mov_b32 s20, s64
  s_mov_b32 s21, s65
  s_mov_b32 s22, 4194304
  s_mov_b32 s23, 0x20000
  v_and_b32 v2, 31, v1
  v_and_b32 v3, 15, v1
  v_lshrrev_b32 v4, 5, v1
  v_xor_b32 v3, v3, v4
  v_lshlrev_b32 v3, 4, v3
  v_lshl_add_u32 v2, v2, 8, v3
  s_and_b32 s7, s4, 1
  s_lshl_b32 s7, s7, 16
  v_add_u32 v2, s7, v2
  v_xor_b32 v88, 0, v2
  v_xor_b32 v89, 32, v2
  v_xor_b32 v90, 64, v2
  v_xor_b32 v91, 96, v2
  v_xor_b32 v92, 128, v2
  v_xor_b32 v93, 160, v2
  v_xor_b32 v94, 192, v2
  v_xor_b32 v95, 224, v2
  v_mov_b32 v20, 0
  v_mov_b32 v21, 0
  v_mov_b32 v22, 0
  v_mov_b32 v23, 0
  v_mov_b32 v24, 0
  v_mov_b32 v25, 0
  v_mov_b32 v26, 0
  v_mov_b32 v27, 0
  v_mov_b32 v28, 0
  v_mov_b32 v29, 0
  v_mov_b32 v30, 0
  v_mov_b32 v31, 0
  v_mov_b32 v32, 0
  v_mov_b32 v33, 0
  v_mov_b32 v34, 0
  v_mov_b32 v35, 0
  v_mov_b32 v36, 0
  v_mov_b32 v37, 0
  v_mov_b32 v38, 0
  v_mov_b32 v39, 0
  v_mov_b32 v40, 0
  v_mov_b32 v41, 0
  v_mov_b32 v42, 0
  v_mov_b32 v43, 0
  v_mov_b32 v44, 0
  v_mov_b32 v45, 0
  v_mov_b32 v46, 0
  v_mov_b32 v47, 0
  v_mov_b32 v48, 0
  v_mov_b32 v49, 0
  v_mov_b32 v50, 0
  v_mov_b32 v51, 0
  s_waitcnt lgkmcnt(0)
  s_waitcnt vmcnt(6)
  s_barrier
  ds_read_b128 v[96:99], v88 offset:0
  ds_read_b128 v[100:103], v88 offset:8192
  ds_read_b128 v[104:107], v89 offset:0
  ds_read_b128 v[108:111], v89 offset:8192
  s_waitcnt lgkmcnt(2)
  v_mfma_f32_32x32x16_bf16 v[20:35], v[128:131], v[96:99], v[20:35]
  ds_read_b128 v[112:115], v90 offset:0
  ds_read_b128 v[116:119], v90 offset:8192
  v_mfma_f32_32x32x16_bf16 v[36:51], v[128:131], v[100:103], v[36:51]
  s_add_u32 m0, s60, 32768
  s_add_u32 s3, s61, 512
  buffer_load_dwordx4 v124, s[8:11], s3 offen lds
  s_and_b32 s7, s4, 1
  s_lshl_b32 s7, s7, 5
  s_lshl_b32 s38, s5, 6
  s_add_u32 s7, s7, s38
  v_and_b32 v2, 31, v1
  v_add_u32 v2, s7, v2
  v_lshlrev_b32 v2, 11, v2
  s_waitcnt lgkmcnt(2)
  v_mfma_f32_32x32x16_bf16 v[20:35], v[132:135], v[104:107], v[20:35]
  ds_read_b128 v[96:99], v91 offset:0
  ds_read_b128 v[100:103], v91 offset:8192
  v_mfma_f32_32x32x16_bf16 v[36:51], v[132:135], v[108:111], v[36:51]
  s_add_u32 m0, s60, 33792
  s_add_u32 s3, s61, 512
  buffer_load_dwordx4 v125, s[8:11], s3 offen lds
  v_lshrrev_b32 v3, 5, v1
  v_lshl_add_u32 v2, v3, 3, v2
  s_lshr_b32 s7, s4, 1
  s_lshl_b32 s7, s7, 6
  s_lshl_b32 s38, s6, 8
  s_add_u32 s7, s7, s38
  v_add_u32 v120, s7, v2
  s_waitcnt lgkmcnt(2)
  v_mfma_f32_32x32x16_bf16 v[20:35], v[136:139], v[112:115], v[20:35]
  ds_read_b128 v[104:107], v92 offset:0
  ds_read_b128 v[108:111], v92 offset:8192
  v_mfma_f32_32x32x16_bf16 v[36:51], v[136:139], v[116:119], v[36:51]
  s_add_u32 m0, s60, 34816
  s_add_u32 s3, s61, 512
  buffer_load_dwordx4 v126, s[8:11], s3 offen lds
  s_and_b32 s7, s4, 1
  s_lshl_b32 s7, s7, 7
  v_and_b32 v2, 31, v1
  v_lshlrev_b32 v2, 2, v2
  v_add_u32 v121, s7, v2
  v_lshrrev_b32 v2, 3, v1
  s_lshl_b32 s7, s4, 4
  s_waitcnt lgkmcnt(2)
  v_mfma_f32_32x32x16_bf16 v[20:35], v[140:143], v[96:99], v[20:35]
  ds_read_b128 v[112:115], v93 offset:0
  ds_read_b128 v[116:119], v93 offset:8192
  v_mfma_f32_32x32x16_bf16 v[36:51], v[140:143], v[100:103], v[36:51]
  s_add_u32 m0, s60, 35840
  s_add_u32 s3, s61, 512
  buffer_load_dwordx4 v127, s[8:11], s3 offen lds
  s_lshl_b32 s38, s6, 7
  s_add_u32 s7, s7, s38
  v_add_u32 v2, s7, v2
  v_lshlrev_b32 v2, 12, v2
  v_and_b32 v3, 7, v1
  v_lshl_add_u32 v122, v3, 4, v2
  s_waitcnt lgkmcnt(2)
  v_mfma_f32_32x32x16_bf16 v[20:35], v[144:147], v[104:107], v[20:35]
  ds_read_b128 v[96:99], v94 offset:0
  ds_read_b128 v[100:103], v94 offset:8192
  v_mfma_f32_32x32x16_bf16 v[36:51], v[144:147], v[108:111], v[36:51]
  s_waitcnt lgkmcnt(2)
  v_mfma_f32_32x32x16_bf16 v[20:35], v[148:151], v[112:115], v[20:35]
  ds_read_b128 v[104:107], v95 offset:0
  ds_read_b128 v[108:111], v95 offset:8192
  v_mfma_f32_32x32x16_bf16 v[36:51], v[148:151], v[116:119], v[36:51]
  s_waitcnt vmcnt(4)
  s_barrier
  s_cmp_lg_u32 s4, 0
  s_cbranch_scc1 pub_38
  s_lshl_b32 s7, s32, 6
  s_add_u32 s7, s7, 17874944
  v_mov_b32 v2, 0
  v_mov_b32 v3, s100
  s_mov_b64 exec, 1
  buffer_store_dword v3, v2, s[28:31], s7 offen sc1
  s_mov_b64 exec, -1
pub_38:
  s_waitcnt lgkmcnt(2)
  v_mfma_f32_32x32x16_bf16 v[20:35], v[152:155], v[96:99], v[20:35]
  ds_read_b128 v[112:115], v88 offset:16384
  ds_read_b128 v[116:119], v88 offset:24576
  v_mfma_f32_32x32x16_bf16 v[36:51], v[152:155], v[100:103], v[36:51]
  s_add_u32 m0, s60, 49152
  s_add_u32 s3, s61, 768
  buffer_load_dwordx4 v124, s[8:11], s3 offen lds
  s_waitcnt lgkmcnt(2)
  v_mfma_f32_32x32x16_bf16 v[20:35], v[156:159], v[104:107], v[20:35]
  ds_read_b128 v[96:99], v89 offset:16384
  ds_read_b128 v[100:103], v89 offset:24576
  v_mfma_f32_32x32x16_bf16 v[36:51], v[156:159], v[108:111], v[36:51]
  s_add_u32 m0, s60, 50176
  s_add_u32 s3, s61, 768
  buffer_load_dwordx4 v125, s[8:11], s3 offen lds
  s_waitcnt lgkmcnt(2)
  v_mfma_f32_32x32x16_bf16 v[20:35], v[160:163], v[112:115], v[20:35]
  ds_read_b128 v[104:107], v90 offset:16384
  ds_read_b128 v[108:111], v90 offset:24576
  v_mfma_f32_32x32x16_bf16 v[36:51], v[160:163], v[116:119], v[36:51]
  s_add_u32 m0, s60, 51200
  s_add_u32 s3, s61, 768
  buffer_load_dwordx4 v126, s[8:11], s3 offen lds
  s_waitcnt lgkmcnt(2)
  v_mfma_f32_32x32x16_bf16 v[20:35], v[164:167], v[96:99], v[20:35]
  ds_read_b128 v[112:115], v91 offset:16384
  ds_read_b128 v[116:119], v91 offset:24576
  v_mfma_f32_32x32x16_bf16 v[36:51], v[164:167], v[100:103], v[36:51]
  s_add_u32 m0, s60, 52224
  s_add_u32 s3, s61, 768
  buffer_load_dwordx4 v127, s[8:11], s3 offen lds
  s_waitcnt lgkmcnt(2)
  v_mfma_f32_32x32x16_bf16 v[20:35], v[168:171], v[104:107], v[20:35]
  ds_read_b128 v[96:99], v92 offset:16384
  ds_read_b128 v[100:103], v92 offset:24576
  v_mfma_f32_32x32x16_bf16 v[36:51], v[168:171], v[108:111], v[36:51]
  buffer_load_dwordx2 v[64:65], v120, s[20:23], 0 offen offset:0
  buffer_load_dwordx2 v[66:67], v120, s[20:23], 0 offen offset:16
  buffer_load_dwordx2 v[68:69], v120, s[20:23], 0 offen offset:32
  buffer_load_dwordx2 v[70:71], v120, s[20:23], 0 offen offset:48
  s_lshl_b32 s7, s5, 8
  s_add_u32 s7, s7, 17039360
  buffer_load_dword v7, v121, s[28:31], s7 offen
  s_waitcnt lgkmcnt(2)
  v_mfma_f32_32x32x16_bf16 v[20:35], v[172:175], v[112:115], v[20:35]
  ds_read_b128 v[104:107], v93 offset:16384
  ds_read_b128 v[108:111], v93 offset:24576
  v_mfma_f32_32x32x16_bf16 v[36:51], v[172:175], v[116:119], v[36:51]
  v_and_b32 v10, 31, v1
  v_lshlrev_b32 v10, 6, v10
  s_lshl_b32 s95, s6, 11
  s_add_u32 s95, s95, 17874944
  s_waitcnt lgkmcnt(2)
  v_mfma_f32_32x32x16_bf16 v[20:35], v[176:179], v[96:99], v[20:35]
  ds_read_b128 v[112:115], v94 offset:16384
  ds_read_b128 v[116:119], v94 offset:24576
  v_mfma_f32_32x32x16_bf16 v[36:51], v[176:179], v[100:103], v[36:51]
  s_waitcnt lgkmcnt(2)
  v_mfma_f32_32x32x16_bf16 v[20:35], v[180:183], v[104:107], v[20:35]
  ds_read_b128 v[96:99], v95 offset:16384
  ds_read_b128 v[100:103], v95 offset:24576
  v_mfma_f32_32x32x16_bf16 v[36:51], v[180:183], v[108:111], v[36:51]
  s_waitcnt vmcnt(9)
  s_barrier
  s_waitcnt lgkmcnt(2)
  v_mfma_f32_32x32x16_bf16 v[20:35], v[184:187], v[112:115], v[20:35]
  ds_read_b128 v[104:107], v88 offset:32768
  ds_read_b128 v[108:111], v88 offset:40960
  v_mfma_f32_32x32x16_bf16 v[36:51], v[184:187], v[116:119], v[36:51]
  s_waitcnt lgkmcnt(2)
  v_mfma_f32_32x32x16_bf16 v[20:35], v[188:191], v[96:99], v[20:35]
  ds_read_b128 v[112:115], v89 offset:32768
  ds_read_b128 v[116:119], v89 offset:40960
  v_mfma_f32_32x32x16_bf16 v[36:51], v[188:191], v[100:103], v[36:51]
  s_waitcnt lgkmcnt(2)
  v_mfma_f32_32x32x16_bf16 v[20:35], v[192:195], v[104:107], v[20:35]
  ds_read_b128 v[96:99], v90 offset:32768
  ds_read_b128 v[100:103], v90 offset:40960
  v_mfma_f32_32x32x16_bf16 v[36:51], v[192:195], v[108:111], v[36:51]
  s_waitcnt lgkmcnt(2)
  v_mfma_f32_32x32x16_bf16 v[20:35], v[196:199], v[112:115], v[20:35]
  ds_read_b128 v[104:107], v91 offset:32768
  ds_read_b128 v[108:111], v91 offset:40960
  v_mfma_f32_32x32x16_bf16 v[36:51], v[196:199], v[116:119], v[36:51]
  s_waitcnt lgkmcnt(2)
  v_mfma_f32_32x32x16_bf16 v[20:35], v[200:203], v[96:99], v[20:35]
  ds_read_b128 v[112:115], v92 offset:32768
  ds_read_b128 v[116:119], v92 offset:40960
  v_mfma_f32_32x32x16_bf16 v[36:51], v[200:203], v[100:103], v[36:51]
  s_waitcnt lgkmcnt(2)
  v_mfma_f32_32x32x16_bf16 v[20:35], v[204:207], v[104:107], v[20:35]
  ds_read_b128 v[96:99], v93 offset:32768
  ds_read_b128 v[100:103], v93 offset:40960
  v_mfma_f32_32x32x16_bf16 v[36:51], v[204:207], v[108:111], v[36:51]
  s_waitcnt lgkmcnt(2)
  v_mfma_f32_32x32x16_bf16 v[20:35], v[208:211], v[112:115], v[20:35]
  ds_read_b128 v[104:107], v94 offset:32768
  ds_read_b128 v[108:111], v94 offset:40960
  v_mfma_f32_32x32x16_bf16 v[36:51], v[208:211], v[116:119], v[36:51]
  s_waitcnt lgkmcnt(2)
  v_mfma_f32_32x32x16_bf16 v[20:35], v[212:215], v[96:99], v[20:35]
  ds_read_b128 v[112:115], v95 offset:32768
  ds_read_b128 v[116:119], v95 offset:40960
  v_mfma_f32_32x32x16_bf16 v[36:51], v[212:215], v[100:103], v[36:51]
  s_waitcnt vmcnt(5)
  s_barrier
  s_waitcnt lgkmcnt(2)
  v_mfma_f32_32x32x16_bf16 v[20:35], v[216:219], v[104:107], v[20:35]
  ds_read_b128 v[96:99], v88 offset:49152
  ds_read_b128 v[100:103], v88 offset:57344
  v_mfma_f32_32x32x16_bf16 v[36:51], v[216:219], v[108:111], v[36:51]
  s_waitcnt lgkmcnt(2)
  v_mfma_f32_32x32x16_bf16 v[20:35], v[220:223], v[112:115], v[20:35]
  ds_read_b128 v[104:107], v89 offset:49152
  ds_read_b128 v[108:111], v89 offset:57344
  v_mfma_f32_32x32x16_bf16 v[36:51], v[220:223], v[116:119], v[36:51]
  s_waitcnt lgkmcnt(2)
  v_mfma_f32_32x32x16_bf16 v[20:35], v[224:227], v[96:99], v[20:35]
  ds_read_b128 v[112:115], v90 offset:49152
  ds_read_b128 v[116:119], v90 offset:57344
  v_mfma_f32_32x32x16_bf16 v[36:51], v[224:227], v[100:103], v[36:51]
  s_waitcnt lgkmcnt(2)
  v_mfma_f32_32x32x16_bf16 v[20:35], v[228:231], v[104:107], v[20:35]
  ds_read_b128 v[96:99], v91 offset:49152
  ds_read_b128 v[100:103], v91 offset:57344
  v_mfma_f32_32x32x16_bf16 v[36:51], v[228:231], v[108:111], v[36:51]
  s_waitcnt lgkmcnt(2)
  v_mfma_f32_32x32x16_bf16 v[20:35], v[232:235], v[112:115], v[20:35]
  ds_read_b128 v[104:107], v92 offset:49152
  ds_read_b128 v[108:111], v92 offset:57344
  v_mfma_f32_32x32x16_bf16 v[36:51], v[232:235], v[116:119], v[36:51]
  s_waitcnt lgkmcnt(2)
  v_mfma_f32_32x32x16_bf16 v[20:35], v[236:239], v[96:99], v[20:35]
  ds_read_b128 v[112:115], v93 offset:49152
  ds_read_b128 v[116:119], v93 offset:57344
  v_mfma_f32_32x32x16_bf16 v[36:51], v[236:239], v[100:103], v[36:51]
  buffer_load_dword v11, v10, s[28:31], s95 offen sc1
  s_waitcnt lgkmcnt(2)
  v_mfma_f32_32x32x16_bf16 v[20:35], v[240:243], v[104:107], v[20:35]
  ds_read_b128 v[96:99], v94 offset:49152
  ds_read_b128 v[100:103], v94 offset:57344
  v_mfma_f32_32x32x16_bf16 v[36:51], v[240:243], v[108:111], v[36:51]
  s_waitcnt lgkmcnt(2)
  v_mfma_f32_32x32x16_bf16 v[20:35], v[244:247], v[112:115], v[20:35]
  ds_read_b128 v[104:107], v95 offset:49152
  ds_read_b128 v[108:111], v95 offset:57344
  v_mfma_f32_32x32x16_bf16 v[36:51], v[244:247], v[116:119], v[36:51]
  s_waitcnt lgkmcnt(2)
  v_mfma_f32_32x32x16_bf16 v[20:35], v[248:251], v[96:99], v[20:35]
  v_mfma_f32_32x32x16_bf16 v[36:51], v[248:251], v[100:103], v[36:51]
  s_waitcnt lgkmcnt(0)
  v_mfma_f32_32x32x16_bf16 v[20:35], v[252:255], v[104:107], v[20:35]
  v_mfma_f32_32x32x16_bf16 v[36:51], v[252:255], v[108:111], v[36:51]
  s_setprio 0
  s_waitcnt vmcnt(0)
  s_mov_b32 s3, 0
fcp_40:
  v_cmp_ne_u32 vcc, s100, v11
  s_nop 4
  s_cmp_eq_u64 vcc, 0
  s_cbranch_scc1 fc_39
  s_add_u32 s3, s3, 1
  s_cmp_ge_u32 s3, 200000
  s_cbranch_scc1 fc_39
  s_sleep 1
  buffer_load_dword v11, v10, s[28:31], s95 offen sc1
  s_waitcnt vmcnt(0)
  s_branch fcp_40
fc_39:
  s_add_u32 m0, s34, 131072
  s_lshl_b32 s3, s5, 7
  s_add_u32 s3, s3, 12582912
  buffer_load_dwordx4 v122, s[28:31], s3 offen lds
  s_add_u32 m0, m0, 1024
  s_add_u32 s3, s3, 32768
  buffer_load_dwordx4 v122, s[28:31], s3 offen lds
  s_mov_b32 s24, s88
  s_mov_b32 s25, s89
  s_mov_b32 s26, 4194304
  s_mov_b32 s27, 0x20000
  s_waitcnt vmcnt(3)
  v_lshlrev_b32 v2, 4, v1
  s_lshl_b32 s7, s4, 12
  v_add_u32 v10, s7, v2
  s_bitcmp1_b32 s4, 0
  s_cbranch_scc0 gr_41
  ds_write_b128 v10, v[20:23] offset:0
  ds_write_b128 v10, v[24:27] offset:1024
  ds_write_b128 v10, v[28:31] offset:2048
  ds_write_b128 v10, v[32:35] offset:3072
  s_nop 1
  v_mov_b32 v20, v36
  v_mov_b32 v21, v37
  v_mov_b32 v22, v38
  v_mov_b32 v23, v39
  v_mov_b32 v24, v40
  v_mov_b32 v25, v41
  v_mov_b32 v26, v42
  v_mov_b32 v27, v43
  v_mov_b32 v28, v44
  v_mov_b32 v29, v45
  v_mov_b32 v30, v46
  v_mov_b32 v31, v47
  v_mov_b32 v32, v48
  v_mov_b32 v33, v49
  v_mov_b32 v34, v50
  v_mov_b32 v35, v51
  s_branch gr_42
gr_41:
  ds_write_b128 v10, v[36:39] offset:0
  ds_write_b128 v10, v[40:43] offset:1024
  ds_write_b128 v10, v[44:47] offset:2048
  ds_write_b128 v10, v[48:51] offset:3072
gr_42:
  v_xor_b32 v10, 4096, v10
  v_cvt_pk_bf16_f32 v7, v7, v7
  v_lshlrev_b32 v7, 16, v7
  v_mul_f32 v7, 3216550459, v7
  v_exp_f32 v7, v7
  s_nop 0
  v_add_f32 v7, 1.0, v7
  v_rcp_f32 v7, v7
  s_nop 0
  v_cvt_pk_bf16_f32 v7, v7, v7
  v_lshlrev_b32 v7, 16, v7
  v_sub_f32 v9, 1.0, v7
  v_lshlrev_b32 v72, 16, v64
  v_and_b32 v73, 0xffff0000, v64
  v_lshlrev_b32 v74, 16, v65
  v_and_b32 v75, 0xffff0000, v65
  v_lshlrev_b32 v76, 16, v66
  v_and_b32 v77, 0xffff0000, v66
  v_lshlrev_b32 v78, 16, v67
  v_and_b32 v79, 0xffff0000, v67
  v_lshlrev_b32 v80, 16, v68
  v_and_b32 v81, 0xffff0000, v68
  v_lshlrev_b32 v82, 16, v69
  v_and_b32 v83, 0xffff0000, v69
  v_lshlrev_b32 v84, 16, v70
  v_and_b32 v85, 0xffff0000, v70
  v_lshlrev_b32 v86, 16, v71
  v_and_b32 v87, 0xffff0000, v71
  v_mul_f32 v72, v72, v7
  v_mul_f32 v73, v73, v7
  v_mul_f32 v74, v74, v7
  v_mul_f32 v75, v75, v7
  v_mul_f32 v76, v76, v7
  v_mul_f32 v77, v77, v7
  v_mul_f32 v78, v78, v7
  v_mul_f32 v79, v79, v7
  v_mul_f32 v80, v80, v7
  v_mul_f32 v81, v81, v7
  v_mul_f32 v82, v82, v7
  v_mul_f32 v83, v83, v7
  v_mul_f32 v84, v84, v7
  v_mul_f32 v85, v85, v7
  v_mul_f32 v86, v86, v7
  v_mul_f32 v87, v87, v7
  v_bfe_u32 v2, v1, 2, 2
  v_lshrrev_b32 v3, 5, v1
  v_lshl_add_u32 v2, v3, 2, v2
  s_lshr_b32 s7, s4, 1
  s_lshl_b32 s7, s7, 5
  v_add_u32 v2, s7, v2
  v_lshlrev_b32 v2, 7, v2
  v_bfe_u32 v3, v1, 4, 1
  v_lshl_add_u32 v2, v3, 5, v2
  v_and_b32 v3, 3, v1
  v_lshl_add_u32 v2, v3, 3, v2
  s_and_b32 s7, s4, 1
  s_lshl_b32 s7, s7, 6
  s_add_u32 s7, s7, 131072
  v_add_u32 v2, s7, v2
  s_waitcnt vmcnt(0)
  s_waitcnt lgkmcnt(0)
  s_barrier
  ds_read_b128 v[128:131], v10 offset:0
  ds_read_b128 v[132:135], v10 offset:1024
  ds_read_b128 v[136:139], v10 offset:2048
  ds_read_b128 v[140:143], v10 offset:3072
  ds_read_b64_tr_b16 v[96:97], v2 offset:0
  ds_read_b64_tr_b16 v[98:99], v2 offset:1024
  ds_read_b64_tr_b16 v[100:101], v2 offset:2048
  ds_read_b64_tr_b16 v[102:103], v2 offset:3072
  s_waitcnt lgkmcnt(4)
  v_add_f32 v20, v20, v128
  v_add_f32 v21, v21, v129
  v_add_f32 v22, v22, v130
  v_add_f32 v23, v23, v131
  v_add_f32 v24, v24, v132
  v_add_f32 v25, v25, v133
  v_add_f32 v26, v26, v134
  v_add_f32 v27, v27, v135
  v_add_f32 v28, v28, v136
  v_add_f32 v29, v29, v137
  v_add_f32 v30, v30, v138
  v_add_f32 v31, v31, v139
  v_add_f32 v32, v32, v140
  v_add_f32 v33, v33, v141
  v_add_f32 v34, v34, v142
  v_add_f32 v35, v35, v143
  v_mul_f32 v20, v20, v9
  v_mul_f32 v21, v21, v9
  v_mul_f32 v22, v22, v9
  v_mul_f32 v23, v23, v9
  v_mul_f32 v24, v24, v9
  v_mul_f32 v25, v25, v9
  v_mul_f32 v26, v26, v9
  v_mul_f32 v27, v27, v9
  v_mul_f32 v28, v28, v9
  v_mul_f32 v29, v29, v9
  v_mul_f32 v30, v30, v9
  v_mul_f32 v31, v31, v9
  v_mul_f32 v32, v32, v9
  v_mul_f32 v33, v33, v9
  v_mul_f32 v34, v34, v9
  v_mul_f32 v35, v35, v9
  s_waitcnt lgkmcnt(0)
  v_lshlrev_b32 v176, 16, v96
  v_and_b32 v177, 0xffff0000, v96
  v_lshlrev_b32 v178, 16, v97
  v_and_b32 v179, 0xffff0000, v97
  v_lshlrev_b32 v180, 16, v98
  v_and_b32 v181, 0xffff0000, v98
  v_lshlrev_b32 v182, 16, v99
  v_and_b32 v183, 0xffff0000, v99
  v_lshlrev_b32 v184, 16, v100
  v_and_b32 v185, 0xffff0000, v100
  v_lshlrev_b32 v186, 16, v101
  v_and_b32 v187, 0xffff0000, v101
  v_lshlrev_b32 v188, 16, v102
  v_and_b32 v189, 0xffff0000, v102
  v_lshlrev_b32 v190, 16, v103
  v_and_b32 v191, 0xffff0000, v103
  v_fma_f32 v20, v176, v72, v20
  v_fma_f32 v21, v177, v73, v21
  v_fma_f32 v22, v178, v74, v22
  v_fma_f32 v23, v179, v75, v23
  v_fma_f32 v24, v180, v76, v24
  v_fma_f32 v25, v181, v77, v25
  v_fma_f32 v26, v182, v78, v26
  v_fma_f32 v27, v183, v79, v27
  v_fma_f32 v28, v184, v80, v28
  v_fma_f32 v29, v185, v81, v29
  v_fma_f32 v30, v186, v82, v30
  v_fma_f32 v31, v187, v83, v31
  v_fma_f32 v32, v188, v84, v32
  v_fma_f32 v33, v189, v85, v33
  v_fma_f32 v34, v190, v86, v34
  v_fma_f32 v35, v191, v87, v35
  v_cvt_pk_bf16_f32 v192, v20, v21
  v_cvt_pk_bf16_f32 v193, v22, v23
  v_cvt_pk_bf16_f32 v194, v24, v25
  v_cvt_pk_bf16_f32 v195, v26, v27
  v_cvt_pk_bf16_f32 v196, v28, v29
  v_cvt_pk_bf16_f32 v197, v30, v31
  v_cvt_pk_bf16_f32 v198, v32, v33
  v_cvt_pk_bf16_f32 v199, v34, v35
  s_and_b32 s7, s4, 1
  s_lshl_b32 s7, s7, 5
  v_and_b32 v2, 31, v1
  v_add_u32 v2, s7, v2
  v_and_b32 v3, 15, v2
  s_lshr_b32 s7, s4, 1
  s_lshl_b32 s7, s7, 2
  v_xor_b32 v3, s7, v3
  v_lshlrev_b32 v3, 4, v3
  v_lshl_add_u32 v2, v2, 8, v3
  v_lshrrev_b32 v3, 5, v1
  v_lshl_add_u32 v2, v3, 3, v2
  v_add_u32 v2, 32768, v2
  v_xor_b32 v3, 0, v2
  ds_write_b64 v3, v[192:193]
  v_xor_b32 v3, 16, v2
  ds_write_b64 v3, v[194:195]
  v_xor_b32 v3, 32, v2
  ds_write_b64 v3, v[196:197]
  v_xor_b32 v3, 48, v2
  ds_write_b64 v3, v[198:199]
  v_lshrrev_b32 v2, 4, v1
  s_lshl_b32 s7, s4, 3
  v_add_u32 v2, s7, v2
  v_and_b32 v4, 15, v1
  v_and_b32 v3, 15, v2
  v_xor_b32 v3, v3, v4
  v_lshlrev_b32 v3, 4, v3
  v_lshl_add_u32 v3, v2, 8, v3
  v_add_u32 v3, 32768, v3
  v_xor_b32 v5, 64, v3
  s_lshl_b32 s3, s5, 6
  v_add_u32 v2, s3, v2
  v_lshlrev_b32 v2, 11, v2
  v_lshl_add_u32 v2, v4, 4, v2
  s_lshl_b32 s7, s6, 8
  s_waitcnt lgkmcnt(0)
  s_barrier
  ds_read_b128 v[192:195], v3
  ds_read_b128 v[196:199], v5 offset:1024
  s_waitcnt lgkmcnt(1)
  buffer_store_dwordx4 v[192:195], v2, s[24:27], s7 offen sc1
  s_add_u32 s7, s7, 8192
  s_waitcnt lgkmcnt(0)
  buffer_store_dwordx4 v[196:199], v2, s[24:27], s7 offen sc1
gated_mix__ssm_conv_h3__grouped_kv_mqa__prompt_kernel_exit:
  s_endpgm
fallback_26:
  s_mov_b32 s101, 1
  s_waitcnt vmcnt(0) lgkmcnt(0)
  s_setprio 0
  v_and_b32 v2, 3, v1
  v_bfe_u32 v3, v1, 2, 1
  v_bfe_u32 v4, v1, 4, 1
  v_xor_b32 v3, v3, v4
  v_or_b32 v2, v2, v3
  v_cmp_eq_u32 vcc, 0, v2
  v_mov_b32 v2, 0x3f803f80
  v_lshlrev_b32 v20, 4, v1
  v_cndmask_b32 v140, 0, v2, vcc
  v_mov_b32 v141, v140
  v_mov_b32 v142, v140
  v_mov_b32 v143, v140
  s_lshr_b32 s16, s4, 1
  s_and_b32 s17, s4, 1
  s_lshl_b32 s18, s32, 2
  s_add_u32 s18, s18, s16
  s_lshl_b32 s7, s18, 12
  s_add_u32 s8, s72, s7
  s_addc_u32 s9, s73, 0
  s_mov_b32 s10, 4096
  s_mov_b32 s11, 0x20000
  s_add_u32 s7, s7, 4194304
  s_add_u32 s12, s92, s7
  s_addc_u32 s13, s93, 0
  s_mov_b32 s14, 4096
  s_mov_b32 s15, 0x20000
  s_mul_i32 s19, s16, 25920
  s_add_u32 s19, s19, 39616
  s_cmp_eq_u32 s16, 0
  s_cselect_b32 s19, 0, s19
  v_lshlrev_b32 v2, 4, v1
  v_add_u32 v144, -64, v2
  s_lshl_b32 s7, s17, 10
  v_add_u32 v145, s7, v2
  v_cmp_le_u32 vcc, 1, v1
  v_mov_b32 v2, 1
  v_mov_b32 v3, 0
  v_addc_co_u32 v2, vcc, 0, v2, vcc
  v_cmp_le_u32 vcc, 1, v1
  s_nop 1
  v_cndmask_b32 v3, 0, 1, vcc
  v_cmp_le_u32 vcc, 3, v1
  s_nop 1
  v_addc_co_u32 v2, vcc, 0, v2, vcc
  v_cmp_le_u32 vcc, 3, v1
  s_nop 1
  v_cndmask_b32 v3, v3, 3, vcc
  v_sub_u32 v3, v1, v3
  v_sub_u32 v4, v3, v2
  v_add_u32 v4, 4, v4
  v_lshlrev_b32 v4, 2, v4
  v_mul_u32_u24 v164, 4160, v2
  v_add_u32 v164, v164, v4
  v_add_u32 v164, 48, v164
  v_add_u32 v164, s19, v164
  v_lshlrev_b32 v165, 2, v3
  v_lshrrev_b32 v2, 1, v2
  v_cmp_eq_u32 vcc, s17, v2
  s_nop 1
  s_and_b64 s[26:27], vcc, 0x3f
  v_and_b32 v2, 15, v1
  v_and_b32 v3, 7, v2
  v_lshlrev_b32 v3, 7, v3
  v_lshrrev_b32 v2, 3, v2
  v_lshl_add_u32 v166, v2, 11, v3
  s_lshr_b32 s7, s2, 3
  s_and_b32 s7, s7, 31
  s_lshl_b32 s7, s7, 16
  s_lshl_b32 s3, s4, 13
  s_add_u32 s95, s7, s3
  s_and_b32 s3, s2, 1
  s_lshl_b32 s3, s3, 10
  s_add_u32 s95, s95, s3
  v_and_b32 v2, 15, v1
  v_lshlrev_b32 v167, 7, v2
  v_mov_b32 v92, 0xff800000
  s_lshl_b32 s23, s4, 12
  s_add_u32 s22, s23, 16777216
  s_mov_b32 s20, 0
maxp_43:
  s_barrier
  s_mov_b32 m0, s23
  s_nop 0
  buffer_load_dwordx4 v20, s[28:31], s22 offen offset:0 lds
  buffer_load_dwordx4 v20, s[28:31], s22 offen offset:1024 lds
  s_waitcnt vmcnt(0)
  s_barrier
  ds_read_b128 v[108:111], v20 offset:0
  ds_read_b128 v[112:115], v20 offset:1024
  s_waitcnt lgkmcnt(0)
  v_mfma_f32_32x32x16_bf16 v[60:75], v[108:111], v[12:15], 0
  v_mfma_f32_32x32x16_bf16 v[60:75], v[112:115], v[16:19], v[60:75]
  s_nop 15
  v_max3_f32 v92, v60, v61, v92
  v_max3_f32 v92, v62, v63, v92
  v_max3_f32 v92, v64, v65, v92
  v_max3_f32 v92, v66, v67, v92
  v_max3_f32 v92, v68, v69, v92
  v_max3_f32 v92, v70, v71, v92
  v_max3_f32 v92, v72, v73, v92
  v_max3_f32 v92, v74, v75, v92
  ds_read_b128 v[108:111], v20 offset:4096
  ds_read_b128 v[112:115], v20 offset:5120
  s_waitcnt lgkmcnt(0)
  v_mfma_f32_32x32x16_bf16 v[60:75], v[108:111], v[12:15], 0
  v_mfma_f32_32x32x16_bf16 v[60:75], v[112:115], v[16:19], v[60:75]
  s_nop 15
  v_max3_f32 v92, v60, v61, v92
  v_max3_f32 v92, v62, v63, v92
  v_max3_f32 v92, v64, v65, v92
  v_max3_f32 v92, v66, v67, v92
  v_max3_f32 v92, v68, v69, v92
  v_max3_f32 v92, v70, v71, v92
  v_max3_f32 v92, v72, v73, v92
  v_max3_f32 v92, v74, v75, v92
  ds_read_b128 v[108:111], v20 offset:8192
  ds_read_b128 v[112:115], v20 offset:9216
  s_waitcnt lgkmcnt(0)
  v_mfma_f32_32x32x16_bf16 v[60:75], v[108:111], v[12:15], 0
  v_mfma_f32_32x32x16_bf16 v[60:75], v[112:115], v[16:19], v[60:75]
  s_nop 15
  v_max3_f32 v92, v60, v61, v92
  v_max3_f32 v92, v62, v63, v92
  v_max3_f32 v92, v64, v65, v92
  v_max3_f32 v92, v66, v67, v92
  v_max3_f32 v92, v68, v69, v92
  v_max3_f32 v92, v70, v71, v92
  v_max3_f32 v92, v72, v73, v92
  v_max3_f32 v92, v74, v75, v92
  ds_read_b128 v[108:111], v20 offset:12288
  ds_read_b128 v[112:115], v20 offset:13312
  s_waitcnt lgkmcnt(0)
  v_mfma_f32_32x32x16_bf16 v[60:75], v[108:111], v[12:15], 0
  v_mfma_f32_32x32x16_bf16 v[60:75], v[112:115], v[16:19], v[60:75]
  s_nop 15
  v_max3_f32 v92, v60, v61, v92
  v_max3_f32 v92, v62, v63, v92
  v_max3_f32 v92, v64, v65, v92
  v_max3_f32 v92, v66, v67, v92
  v_max3_f32 v92, v68, v69, v92
  v_max3_f32 v92, v70, v71, v92
  v_max3_f32 v92, v72, v73, v92
  v_max3_f32 v92, v74, v75, v92
  ds_read_b128 v[108:111], v20 offset:16384
  ds_read_b128 v[112:115], v20 offset:17408
  s_waitcnt lgkmcnt(0)
  v_mfma_f32_32x32x16_bf16 v[60:75], v[108:111], v[12:15], 0
  v_mfma_f32_32x32x16_bf16 v[60:75], v[112:115], v[16:19], v[60:75]
  s_nop 15
  v_max3_f32 v92, v60, v61, v92
  v_max3_f32 v92, v62, v63, v92
  v_max3_f32 v92, v64, v65, v92
  v_max3_f32 v92, v66, v67, v92
  v_max3_f32 v92, v68, v69, v92
  v_max3_f32 v92, v70, v71, v92
  v_max3_f32 v92, v72, v73, v92
  v_max3_f32 v92, v74, v75, v92
  ds_read_b128 v[108:111], v20 offset:20480
  ds_read_b128 v[112:115], v20 offset:21504
  s_waitcnt lgkmcnt(0)
  v_mfma_f32_32x32x16_bf16 v[60:75], v[108:111], v[12:15], 0
  v_mfma_f32_32x32x16_bf16 v[60:75], v[112:115], v[16:19], v[60:75]
  s_nop 15
  v_max3_f32 v92, v60, v61, v92
  v_max3_f32 v92, v62, v63, v92
  v_max3_f32 v92, v64, v65, v92
  v_max3_f32 v92, v66, v67, v92
  v_max3_f32 v92, v68, v69, v92
  v_max3_f32 v92, v70, v71, v92
  v_max3_f32 v92, v72, v73, v92
  v_max3_f32 v92, v74, v75, v92
  ds_read_b128 v[108:111], v20 offset:24576
  ds_read_b128 v[112:115], v20 offset:25600
  s_waitcnt lgkmcnt(0)
  v_mfma_f32_32x32x16_bf16 v[60:75], v[108:111], v[12:15], 0
  v_mfma_f32_32x32x16_bf16 v[60:75], v[112:115], v[16:19], v[60:75]
  s_nop 15
  v_max3_f32 v92, v60, v61, v92
  v_max3_f32 v92, v62, v63, v92
  v_max3_f32 v92, v64, v65, v92
  v_max3_f32 v92, v66, v67, v92
  v_max3_f32 v92, v68, v69, v92
  v_max3_f32 v92, v70, v71, v92
  v_max3_f32 v92, v72, v73, v92
  v_max3_f32 v92, v74, v75, v92
  ds_read_b128 v[108:111], v20 offset:28672
  ds_read_b128 v[112:115], v20 offset:29696
  s_waitcnt lgkmcnt(0)
  v_mfma_f32_32x32x16_bf16 v[60:75], v[108:111], v[12:15], 0
  v_mfma_f32_32x32x16_bf16 v[60:75], v[112:115], v[16:19], v[60:75]
  s_nop 15
  v_max3_f32 v92, v60, v61, v92
  v_max3_f32 v92, v62, v63, v92
  v_max3_f32 v92, v64, v65, v92
  v_max3_f32 v92, v66, v67, v92
  v_max3_f32 v92, v68, v69, v92
  v_max3_f32 v92, v70, v71, v92
  v_max3_f32 v92, v72, v73, v92
  v_max3_f32 v92, v74, v75, v92
  s_add_u32 s22, s22, 32768
  s_add_u32 s20, s20, 1
  s_cmp_lt_u32 s20, 8
  s_cbranch_scc1 maxp_43
  v_mov_b32 v93, v92
  s_nop 1
  v_permlane32_swap_b32 v92, v93
  s_nop 1
  v_max_f32 v92, v92, v93
  v_sub_f32 v44, 0, v92
  v_sub_f32 v45, 0, v92
  v_sub_f32 v46, 0, v92
  v_sub_f32 v47, 0, v92
  v_sub_f32 v48, 0, v92
  v_sub_f32 v49, 0, v92
  v_sub_f32 v50, 0, v92
  v_sub_f32 v51, 0, v92
  v_sub_f32 v52, 0, v92
  v_sub_f32 v53, 0, v92
  v_sub_f32 v54, 0, v92
  v_sub_f32 v55, 0, v92
  v_sub_f32 v56, 0, v92
  v_sub_f32 v57, 0, v92
  v_sub_f32 v58, 0, v92
  v_sub_f32 v59, 0, v92
  s_barrier
  s_branch attstart_16
Lend0:
.section .rodata,"a"
.p2align 6
.amdhsa_kernel gated_mix__ssm_conv_h3__grouped_kv_mqa__prompt_kernel
  .amdhsa_next_free_vgpr 256
  .amdhsa_next_free_sgpr 102
  .amdhsa_accum_offset 256
  .amdhsa_group_segment_fixed_size 0
  .amdhsa_kernarg_size 120
  .amdhsa_user_sgpr_count 2
  .amdhsa_user_sgpr_kernarg_segment_ptr 1
  .amdhsa_system_sgpr_workgroup_id_x 1
.end_amdhsa_kernel
.text
```
